```python
import torch

def _softmax(x, axis=-1):
    return torch.softmax(x, dim=axis)
def _gelu(x):
    return torch.nn.functional.gelu(x, approximate="tanh")
def _silu(x):
    return torch.nn.functional.silu(x)
def _sigmoid(x):
    return torch.sigmoid(x)
def _layernorm(x, axis=-1, eps=1e-5):
    m = x.mean(dim=axis, keepdim=True)
    v = x.var(dim=axis, keepdim=True, unbiased=False)
    return (x - m) / torch.sqrt(v + eps)
def _scatter_add(tgt, idx, src, axis=0):
    return tgt.clone().index_add_(axis, idx, src)
def _segment_sum(src, seg, n):
    out = torch.zeros((n,) + src.shape[1:], dtype=src.dtype)
    return out.index_add_(0, seg, src)
def _pad(x, pw):
    flat = tuple(v for pair in reversed(pw) for v in pair)
    return torch.nn.functional.pad(x, flat)

kernel_name = 'recurrent_scan__ssm_conv_s4d__dense_activation_mish__prompt'

def setup_inputs():

    _w = (lambda a: (lambda t: t.to(torch.bfloat16) if t.is_floating_point() else t)(torch.as_tensor(a)))
    def _A_setup():
        Bsz, L, D, N = 1, 2048, 512, 128
        return {
            "u": _w((lambda *s: torch.randn(*s, dtype=torch.bfloat16) * 0.05)(Bsz, L, D)),
            "log_A_real": _w((lambda *s: torch.randn(*s, dtype=torch.bfloat16) * 3.2)(D, N) * 0.5),
            "A_imag": _w((lambda *s: torch.randn(*s, dtype=torch.bfloat16) * 0.2)(D, N) * 3.14),
            "C_real": _w((lambda *s: torch.randn(*s, dtype=torch.bfloat16) * 0.8)(D, N) / N ** 0.5),
            "C_imag": _w((lambda *s: torch.randn(*s, dtype=torch.bfloat16) * 0.8)(D, N) / N ** 0.5),
            "log_dt": _w((lambda *s: torch.randn(*s, dtype=torch.bfloat16) * 0.2)(D) * 0.5 - 4.0),
            "D_skip": _w((lambda *s: torch.randn(*s, dtype=torch.bfloat16) * 0.2)(D)),
        }
    _A_in = _A_setup()

    def _B_setup():
        B, S, D, F = 1, 2048, 512, 1376
        return {
            "x": _w((lambda *s: torch.randn(*s, dtype=torch.bfloat16) * 0.05)(B, S, D)),
            "w1": _w((lambda *s: torch.randn(*s, dtype=torch.bfloat16) * 0.8)(D, F) * (D ** -0.5)),
            "b1": _w((lambda *s: torch.randn(*s, dtype=torch.bfloat16) * 0.4)(F)),
            "w2": _w((lambda *s: torch.randn(*s, dtype=torch.bfloat16) * 0.1)(F, D) * (F ** -0.5)),
        }
    _B_in = _B_setup()

    return {
        "A_u": _A_in["u"],
        "A_log_A_real": _A_in["log_A_real"],
        "A_A_imag": _A_in["A_imag"],
        "A_C_real": _A_in["C_real"],
        "A_C_imag": _A_in["C_imag"],
        "A_log_dt": _A_in["log_dt"],
        "A_D_skip": _A_in["D_skip"],
        "B_x": _B_in["x"],
        "B_w1": _B_in["w1"],
        "B_b1": _B_in["b1"],
        "B_w2": _B_in["w2"],
    }

def reference(A_u, A_log_A_real, A_A_imag, A_C_real, A_C_imag, A_log_dt, A_D_skip, B_x, B_w1, B_b1, B_w2):
    def _A_ref(u, log_A_real, A_imag, C_real, C_imag, log_dt, D_skip):
        L = u.shape[1]
        dt = torch.exp(log_dt)
        A = -torch.exp(log_A_real) + 1j * A_imag
        C = (C_real + 1j * C_imag) * dt[:, None]
        pos = (lambda x, dt: x.to(dt))(torch.arange(L), log_dt.dtype)
        P = torch.exp((A * dt[:, None])[:, :, None] * pos[None, None, :])
        K = 2.0 * torch.einsum("dn,dnl->dl", C, P).real
        L2 = 2 * L
        u_t = (lambda x, *d: x.permute(*d))(u, 0, 2, 1)
        Kf = (lambda x, *a, **k: torch.fft.rfft(x.float(), *a, **k))(K, L2)
        Uf = (lambda x, *a, **k: torch.fft.rfft(x.float(), *a, **k))(u_t, L2)
        y = (lambda x, *a, **k: torch.fft.irfft(x, *a, **k).to(torch.bfloat16))(Uf * Kf[None, :, :], L2)[:, :, :L]
        y = (lambda x, *d: x.permute(*d))(y, 0, 2, 1)
        return y + u * D_skip[None, None, :]

    def _B_ref(x, w1, b1, w2):
        h = torch.einsum("bsd,df->bsf", x, w1) + b1
        sp = torch.log1p(torch.exp(-torch.abs(h))) + torch.where(h > 0, h, torch.zeros_like(h))
        act = h * torch.tanh(sp)
        return torch.einsum("bsf,fd->bsd", act, w2)

    x = A_u
    xn = _layernorm(x, axis=-1)
    s = _A_ref(xn, A_log_A_real, A_A_imag, A_C_real, A_C_imag, A_log_dt, A_D_skip)
    g = _silu(_B_ref(xn, B_w1, B_b1, B_w2))
    return x + s * g
```

```asm
; @launch grid=(256,1,1) block=(256,1,1) lds=163840
.amdgcn_target "amdgcn-amd-amdhsa--gfx950"
.text
.globl recurrent_scan__ssm_conv_s4d__dense_activation_mish__prompt_kernel

.p2align 8
.type recurrent_scan__ssm_conv_s4d__dense_activation_mish__prompt_kernel,@function
recurrent_scan__ssm_conv_s4d__dense_activation_mish__prompt_kernel:
    s_load_dwordx16 s[64:79], s[0:1], 0
    s_load_dwordx8 s[80:87], s[0:1], 64
    s_load_dwordx4 s[88:91], s[0:1], 96
    s_cmp_ge_u32 s2, 256
    s_cbranch_scc1 L_end
    v_and_b32 v1, 63, v0
    s_getpc_b64 s[52:53]
L_pc0:
    s_lshr_b32 s54, s2, 3
    s_mul_i32 s54, s54, 8
    v_add_u32 v44, s54, v0
    s_add_u32 s52, s52, L_main-L_pc0
    s_addc_u32 s53, s53, 0
    v_lshlrev_b32 v42, 7, v44
    v_mov_b32 v43, s53
    v_add_co_u32 v42, vcc, s52, v42
    s_nop 1
    v_addc_co_u32 v43, vcc, 0, v43, vcc
    v_cmp_gt_u32 s[58:59], 8, v0
    v_cmp_gt_u32 vcc, (L_end-L_main)/128, v44
    s_nop 0
    s_and_b64 vcc, vcc, s[58:59]
    s_and_saveexec_b64 s[56:57], vcc
    s_cbranch_execz L_noct
    global_load_dword v44, v[42:43], off
L_noct:
    s_mov_b64 exec, s[56:57]
    v_lshrrev_b32 v2, 6, v0
    s_and_b32 s52, s2, 7
    s_lshr_b32 s53, s2, 3
    v_readfirstlane_b32 s4, v2
    s_lshl_b32 s3, s52, 5
    s_add_u32 s3, s3, s53
    v_lshlrev_b32 v2, 4, v1
    s_lshl_b32 s52, s3, 3
    s_lshl_b32 s53, s4, 1
    s_add_u32 s52, s52, s53
    s_lshl_b32 s52, s52, 10
    s_mov_b32 s10, 0x200000
    s_mov_b32 s11, 0x20000
    s_lshr_b32 s32, s4, 1
    s_and_b32 s33, s4, 1
    s_and_b32 s54, s3, 15
    s_mul_i32 s6, s54, 3
    s_lshl_b32 s55, s54, 1
    s_add_u32 s55, s55, 11
    s_cmp_lt_u32 s54, 11
    s_cselect_b32 s6, s6, s55
    s_cselect_b32 s7, 3, 2
    s_lshr_b32 s5, s3, 4
    s_lshr_b32 s47, s3, 3
    s_and_b32 s48, s3, 7
    s_waitcnt lgkmcnt(0)
    s_mov_b32 s8, s64
    s_mov_b32 s9, s65
    buffer_load_dwordx4 v[34:37], v2, s[8:11], s52 offen
    buffer_load_dwordx4 v[38:41], v2, s[8:11], s52 offen offset:1024
    s_mov_b32 s20, s90
    s_mov_b32 s21, s91
    s_mov_b32 s22, 268435456
    s_mov_b32 s23, 0x20000
    s_mov_b32 s28, s82
    s_mov_b32 s29, s83
    s_mov_b32 s30, 2752
    s_mov_b32 s31, 0x20000
    s_mov_b32 s12, s80
    s_mov_b32 s13, s81
    s_mov_b32 s14, 1409024
    s_mov_b32 s15, 0x20000
    s_mov_b32 s16, s84
    s_mov_b32 s17, s85
    s_mov_b32 s18, 1409024
    s_mov_b32 s19, 0x20000
    s_mov_b32 s24, s86
    s_mov_b32 s25, s87
    s_mov_b32 s26, 0x200000
    s_mov_b32 s27, 0x20000
    s_mov_b64 s[92:93], s[88:89]
    s_lshl_b32 s54, s3, 1
    s_add_u32 s54, s54, s32
    s_lshl_b32 s54, s54, 8
    v_lshlrev_b32 v61, 2, v1
    v_add_u32 v60, s54, v61
    s_lshl_b32 s58, s3, 2
    global_load_dword v46, v60, s[66:67]
    global_load_dword v47, v60, s[68:69]
    global_load_dword v48, v60, s[70:71]
    global_load_dword v49, v60, s[72:73]
    s_load_dword s49, s[74:75], s58
    s_load_dword s50, s[76:77], s58
    v_mov_b32 v60, 12582912
    buffer_load_dword v50, v60, s[20:23], 0 offen sc1
    s_cmp_eq_u32 s4, 1
    s_cbranch_scc0 L_e1_1
    s_lshl_b32 s52, s6, 6
    v_lshlrev_b32 v60, 1, v1
    buffer_load_ushort v51, v60, s[28:31], s52 offen
    buffer_load_ushort v52, v60, s[28:31], s52 offen offset:128
    s_branch L_ee_3
L_e1_1:
    s_mul_i32 s52, s2, 5504
    v_lshlrev_b32 v60, 7, v1
    s_mov_b32 exec_hi, 0x7ff
    s_cmp_eq_u32 s4, 0
    s_cbranch_scc0 L_e2_2
    buffer_load_dword v54, v60, s[12:15], s52 offen
    s_branch L_ee_3
L_e2_2:
    s_cmp_eq_u32 s4, 2
    s_cbranch_scc0 L_ee_3
    buffer_load_dword v54, v60, s[16:19], s52 offen
L_ee_3:
    s_mov_b32 exec_hi, -1
L_main:
    v_add_u32 v62, 0, v1
    v_mul_u32_u24 v63, 171, v62
    v_lshrrev_b32 v63, 11, v63
    v_mul_u32_u24 v56, 12, v63
    v_sub_u32 v56, v62, v56
    v_lshlrev_b32 v56, 4, v56
    v_mul_u32_u24 v63, 2752, v63
    v_add_u32 v56, v56, v63
    v_add_u32 v62, 64, v1
    v_mul_u32_u24 v63, 171, v62
    v_lshrrev_b32 v63, 11, v63
    v_mul_u32_u24 v57, 12, v63
    v_sub_u32 v57, v62, v57
    v_lshlrev_b32 v57, 4, v57
    v_mul_u32_u24 v63, 2752, v63
    v_add_u32 v57, v57, v63
    v_subrev_u32 v57, 1024, v57
    v_add_u32 v62, 128, v1
    v_mul_u32_u24 v63, 171, v62
    v_lshrrev_b32 v63, 11, v63
    v_mul_u32_u24 v58, 12, v63
    v_sub_u32 v58, v62, v58
    v_lshlrev_b32 v58, 4, v58
    v_mul_u32_u24 v63, 2752, v63
    v_add_u32 v58, v58, v63
    v_subrev_u32 v58, 2048, v58
    s_mul_i32 s96, s4, 352256
    s_lshl_b32 s97, s6, 6
    s_add_u32 s96, s96, s97
    s_mul_i32 s97, s4, 24576
    s_add_u32 s97, s97, 0
    s_mov_b32 m0, s97
    s_nop 0
    buffer_load_dwordx4 v56, s[12:15], s96 offen offset:0 lds
    buffer_load_dwordx4 v57, s[12:15], s96 offen offset:1024 lds
    buffer_load_dwordx4 v58, s[12:15], s96 offen offset:2048 lds
    s_add_u32 s96, s96, 44032
    s_add_u32 s97, s97, 3072
    s_mov_b32 m0, s97
    s_nop 0
    buffer_load_dwordx4 v56, s[12:15], s96 offen offset:0 lds
    buffer_load_dwordx4 v57, s[12:15], s96 offen offset:1024 lds
    buffer_load_dwordx4 v58, s[12:15], s96 offen offset:2048 lds
    s_add_u32 s96, s96, 44032
    s_add_u32 s97, s97, 3072
    v_and_b32 v3, 31, v1
    v_lshrrev_b32 v4, 5, v1
    v_mov_b32 v66, 0
    v_mov_b32 v67, 0
    v_mov_b32 v68, 0
    v_mov_b32 v69, 0
    v_lshlrev_b32 v62, 4, v0
    v_add_u32 v62, 155968, v62
    ds_write_b128 v62, v[66:69]
    v_cmp_gt_u32 vcc, 132, v0
    s_nop 0
    s_and_saveexec_b64 s[62:63], vcc
    ds_write_b128 v62, v[66:69] offset:4096
    s_mov_b64 exec, s[62:63]
    s_mul_i32 s52, s4, 14416
    s_add_u32 s52, s52, 98304
    v_lshlrev_b32 v70, 2, v1
    v_add_u32 v70, s52, v70
    v_add_u32 v71, 1088, v70
    v_add_u32 v72, 2176, v70
    v_add_u32 v73, 3264, v70
    v_add_u32 v74, 4352, v70
    v_add_u32 v75, 5440, v70
    v_add_u32 v76, 5712, v70
    v_add_u32 v77, 6800, v70
    v_add_u32 v78, 7888, v70
    v_add_u32 v79, 8976, v70
    v_add_u32 v80, 10064, v70
    v_add_u32 v81, 11152, v70
    v_add_u32 v82, 12240, v70
    v_add_u32 v83, 13328, v70
    v_and_b32 v62, 15, v1
    v_lshrrev_b32 v63, 4, v1
    v_lshlrev_b32 v84, 4, v63
    v_mul_u32_u24 v64, 272, v62
    v_add_u32 v84, v84, v64
    s_mul_i32 s52, s32, 28832
    s_add_u32 s52, s52, 98304
    v_add_u32 v84, s52, v84
    s_mul_i32 s53, s33, 4352
    s_add_u32 s53, s53, 5712
    v_add_u32 v85, s53, v84
    s_lshl_b32 s53, s33, 4
    v_add_u32 v62, s53, v62
    s_mul_i32 s52, s32, 3104
    s_add_u32 s52, s52, 155968
    v_lshlrev_b32 v86, 5, v62
    v_lshlrev_b32 v64, 4, v63
    v_add_u32 v86, v86, v64
    v_lshlrev_b32 v64, 4, v62
    v_add_u32 v64, 1024, v64
    v_cmp_eq_u32 s[54:55], 2, v63
    s_nop 1
    v_cndmask_b32 v86, v86, v64, s[54:55]
    v_lshlrev_b32 v64, 3, v62
    v_add_u32 v64, 1536, v64
    v_cmp_eq_u32 s[54:55], 3, v63
    s_nop 1
    v_cndmask_b32 v86, v86, v64, s[54:55]
    v_mov_b32 v87, 8
    v_mov_b32 v64, 256
    v_cndmask_b32 v87, v87, v64, s[54:55]
    v_add_u32 v86, s52, v86
    v_add_u32 v87, v87, v86
    v_min_u32 v88, 1, v63
    v_lshlrev_b32 v88, 9, v88
    v_lshlrev_b32 v64, 2, v62
    v_add_u32 v88, v88, v64
    v_add_u32 v88, s52, v88
    v_add_u32 v88, 2048, v88
    v_lshlrev_b32 v62, 3, v0
    v_sub_u32 v62, 2033, v62
    v_mov_b32 v65, 768
    s_mov_b32 s34, 128
    v_add_u32 v63, 0, v62
    v_cvt_f32_i32 v64, v63
    v_cmp_gt_i32 s[56:57], 0, v63
    v_cvt_pk_bf16_f32 v64, v64, v64
    v_cmp_gt_i32 s[58:59], s34, v63
    v_and_b32 v64, 0xffff, v64
    v_subrev_u32 v90, 17024, v64
    v_cndmask_b32 v90, v90, v63, s[58:59]
    v_cndmask_b32 v90, v90, v65, s[56:57]
    v_lshlrev_b32 v90, 2, v90
    v_add_u32 v90, 155968, v90
    v_add_u32 v63, 1, v62
    v_cvt_f32_i32 v64, v63
    v_cmp_gt_i32 s[56:57], 0, v63
    v_cvt_pk_bf16_f32 v64, v64, v64
    v_cmp_gt_i32 s[58:59], s34, v63
    v_and_b32 v64, 0xffff, v64
    v_subrev_u32 v91, 17024, v64
    v_cndmask_b32 v91, v91, v63, s[58:59]
    v_cndmask_b32 v91, v91, v65, s[56:57]
    v_lshlrev_b32 v91, 2, v91
    v_add_u32 v91, 155968, v91
    v_add_u32 v63, 2, v62
    v_cvt_f32_i32 v64, v63
    v_cmp_gt_i32 s[56:57], 0, v63
    v_cvt_pk_bf16_f32 v64, v64, v64
    v_cmp_gt_i32 s[58:59], s34, v63
    v_and_b32 v64, 0xffff, v64
    v_subrev_u32 v92, 17024, v64
    v_cndmask_b32 v92, v92, v63, s[58:59]
    v_cndmask_b32 v92, v92, v65, s[56:57]
    v_lshlrev_b32 v92, 2, v92
    v_add_u32 v92, 155968, v92
    v_add_u32 v63, 3, v62
    v_cvt_f32_i32 v64, v63
    v_cmp_gt_i32 s[56:57], 0, v63
    v_cvt_pk_bf16_f32 v64, v64, v64
    v_cmp_gt_i32 s[58:59], s34, v63
    v_and_b32 v64, 0xffff, v64
    v_subrev_u32 v93, 17024, v64
    v_cndmask_b32 v93, v93, v63, s[58:59]
    v_cndmask_b32 v93, v93, v65, s[56:57]
    v_lshlrev_b32 v93, 2, v93
    v_add_u32 v93, 155968, v93
    v_add_u32 v63, 4, v62
    v_cvt_f32_i32 v64, v63
    v_cmp_gt_i32 s[56:57], 0, v63
    v_cvt_pk_bf16_f32 v64, v64, v64
    v_cmp_gt_i32 s[58:59], s34, v63
    v_and_b32 v64, 0xffff, v64
    v_subrev_u32 v94, 17024, v64
    v_cndmask_b32 v94, v94, v63, s[58:59]
    v_cndmask_b32 v94, v94, v65, s[56:57]
    v_lshlrev_b32 v94, 2, v94
    v_add_u32 v94, 155968, v94
    v_add_u32 v63, 5, v62
    v_cvt_f32_i32 v64, v63
    v_cmp_gt_i32 s[56:57], 0, v63
    v_cvt_pk_bf16_f32 v64, v64, v64
    v_cmp_gt_i32 s[58:59], s34, v63
    v_and_b32 v64, 0xffff, v64
    v_subrev_u32 v95, 17024, v64
    v_cndmask_b32 v95, v95, v63, s[58:59]
    v_cndmask_b32 v95, v95, v65, s[56:57]
    v_lshlrev_b32 v95, 2, v95
    v_add_u32 v95, 155968, v95
    v_add_u32 v63, 6, v62
    v_cvt_f32_i32 v64, v63
    v_cmp_gt_i32 s[56:57], 0, v63
    v_cvt_pk_bf16_f32 v64, v64, v64
    v_cmp_gt_i32 s[58:59], s34, v63
    v_and_b32 v64, 0xffff, v64
    v_subrev_u32 v96, 17024, v64
    v_cndmask_b32 v96, v96, v63, s[58:59]
    v_cndmask_b32 v96, v96, v65, s[56:57]
    v_lshlrev_b32 v96, 2, v96
    v_add_u32 v96, 155968, v96
    v_add_u32 v63, 7, v62
    v_cvt_f32_i32 v64, v63
    v_cmp_gt_i32 s[56:57], 0, v63
    v_cvt_pk_bf16_f32 v64, v64, v64
    v_cmp_gt_i32 s[58:59], s34, v63
    v_and_b32 v64, 0xffff, v64
    v_subrev_u32 v97, 17024, v64
    v_cndmask_b32 v97, v97, v63, s[58:59]
    v_cndmask_b32 v97, v97, v65, s[56:57]
    v_lshlrev_b32 v97, 2, v97
    v_add_u32 v97, 155968, v97
    v_add_u32 v63, 8, v62
    v_cvt_f32_i32 v64, v63
    v_cmp_gt_i32 s[56:57], 0, v63
    v_cvt_pk_bf16_f32 v64, v64, v64
    v_cmp_gt_i32 s[58:59], s34, v63
    v_and_b32 v64, 0xffff, v64
    v_subrev_u32 v98, 17024, v64
    v_cndmask_b32 v98, v98, v63, s[58:59]
    v_cndmask_b32 v98, v98, v65, s[56:57]
    v_lshlrev_b32 v98, 2, v98
    v_add_u32 v98, 155968, v98
    v_add_u32 v63, 9, v62
    v_cvt_f32_i32 v64, v63
    v_cmp_gt_i32 s[56:57], 0, v63
    v_cvt_pk_bf16_f32 v64, v64, v64
    v_cmp_gt_i32 s[58:59], s34, v63
    v_and_b32 v64, 0xffff, v64
    v_subrev_u32 v99, 17024, v64
    v_cndmask_b32 v99, v99, v63, s[58:59]
    v_cndmask_b32 v99, v99, v65, s[56:57]
    v_lshlrev_b32 v99, 2, v99
    v_add_u32 v99, 155968, v99
    v_add_u32 v63, 10, v62
    v_cvt_f32_i32 v64, v63
    v_cmp_gt_i32 s[56:57], 0, v63
    v_cvt_pk_bf16_f32 v64, v64, v64
    v_cmp_gt_i32 s[58:59], s34, v63
    v_and_b32 v64, 0xffff, v64
    v_subrev_u32 v100, 17024, v64
    v_cndmask_b32 v100, v100, v63, s[58:59]
    v_cndmask_b32 v100, v100, v65, s[56:57]
    v_lshlrev_b32 v100, 2, v100
    v_add_u32 v100, 155968, v100
    v_lshlrev_b32 v62, 3, v4
    v_bfe_u32 v63, v1, 2, 2
    v_add_u32 v62, v62, v63
    v_mul_u32_u24 v62, 192, v62
    v_bfe_u32 v63, v1, 4, 1
    v_lshlrev_b32 v63, 5, v63
    v_add_u32 v62, v62, v63
    v_and_b32 v63, 3, v1
    v_lshlrev_b32 v63, 3, v63
    v_add_u32 v64, v62, v63
    v_add_u32 v64, 0, v64
    v_add_u32 v65, 49152, v64
    s_lshl_b32 s56, s5, 2
    s_add_u32 s56, s56, s4
    s_lshl_b32 s57, s56, 6
    s_add_u32 s57, s57, 12587008
    v_lshlrev_b32 v62, 3, v1
    v_add_u32 v53, s57, v62
    v_lshlrev_b32 v66, 4, v4
    v_add_u32 v66, 162240, v66
    v_and_b32 v102, 3, v1
    v_mul_u32_u24 v102, 4416, v102
    v_bfe_u32 v103, v1, 2, 3
    v_lshlrev_b32 v103, 3, v103
    v_sub_u32 v102, v102, v103
    v_lshlrev_b32 v105, 4, v4
    v_add_u32 v102, v102, v105
    s_mul_i32 s58, s32, 17664
    s_add_u32 s58, s58, 102464
    s_lshl_b32 s59, s33, 10
    s_sub_u32 s59, s58, s59
    s_sub_u32 s59, s59, 1024
    v_add_u32 v5, s59, v102
    v_subrev_u32 v6, 2048, v5
    s_lshl_b32 s59, s33, 5
    s_sub_u32 s59, s58, s59
    s_add_u32 s59, s59, 32
    v_add_u32 v7, s59, v102
    v_mul_u32_u24 v102, 80, v3
    v_add_u32 v103, v102, v105
    s_mul_i32 s58, s32, 7680
    s_add_u32 s58, s58, 133632
    s_mul_i32 s59, s33, 1280
    s_sub_u32 s59, s58, s59
    s_add_u32 s59, s59, 1280
    v_add_u32 v8, s59, v103
    s_lshl_b32 s59, s33, 5
    s_sub_u32 s59, s58, s59
    s_add_u32 s59, s59, 2592
    v_add_u32 v9, s59, v103
    s_lshl_b32 s59, s4, 12
    s_add_u32 s59, s59, 98304
    v_add_u32 v10, s59, v2
    s_xor_b32 s59, s4, 1
    s_lshl_b32 s59, s59, 12
    s_add_u32 s59, s59, 98304
    v_add_u32 v11, s59, v2
    v_lshlrev_b32 v105, 3, v4
    v_add_u32 v102, v102, v105
    s_mul_i32 s59, s33, 2560
    s_add_u32 s59, s59, s58
    s_add_u32 s59, s59, 2560
    v_add_u32 v12, s59, v102
    v_lshlrev_b32 v102, 6, v3
    v_add_u32 v102, v102, v105
    s_lshl_b32 s59, s4, 11
    s_add_u32 s59, s59, 114688
    v_add_u32 v13, s59, v102
    v_bfe_u32 v14, v1, 1, 2
    v_lshlrev_b32 v14, 4, v14
    v_lshrrev_b32 v102, 2, v1
    v_bfe_u32 v103, v1, 3, 2
    v_and_b32 v105, 3, v1
    v_xor_b32 v103, v103, v105
    v_lshlrev_b32 v103, 4, v103
    v_lshlrev_b32 v102, 6, v102
    v_add_u32 v102, v102, v103
    v_add_u32 v15, s59, v102
    v_lshlrev_b32 v16, 13, v1
    s_lshl_b32 s59, s4, 6
    s_add_u32 s59, s59, 128
    v_add_u32 v102, s59, v1
    v_lshrrev_b32 v103, 2, v102
    v_mul_u32_u24 v103, 80, v103
    v_and_b32 v102, 3, v102
    v_lshlrev_b32 v102, 4, v102
    v_add_u32 v102, v102, v103
    v_add_u32 v17, 133632, v102
    s_lshl_b32 s59, s4, 10
    s_add_u32 s59, s59, 12587008
    v_add_u32 v18, s59, v2
    v_lshrrev_b32 v102, 3, v1
    v_bfe_u32 v103, v1, 4, 1
    v_lshlrev_b32 v103, 2, v103
    v_and_b32 v104, 7, v1
    v_xor_b32 v103, v103, v104
    v_lshlrev_b32 v103, 4, v103
    v_lshlrev_b32 v102, 10, v102
    v_add_u32 v19, v102, v103
    v_lshlrev_b32 v102, 2, v4
    v_bfe_u32 v103, v1, 2, 2
    v_add_u32 v102, v102, v103
    v_lshlrev_b32 v102, 7, v102
    v_bfe_u32 v103, v1, 4, 1
    v_lshlrev_b32 v103, 5, v103
    v_add_u32 v102, v102, v103
    v_and_b32 v103, 3, v1
    v_lshlrev_b32 v103, 3, v103
    v_add_u32 v102, v102, v103
    s_lshl_b32 s59, s32, 11
    v_add_u32 v102, s59, v102
    v_bfe_u32 v103, v1, 3, 1
    v_lshlrev_b32 v103, 6, v103
    v_add_u32 v20, v102, v103
    v_xor_b32 v103, 64, v103
    v_add_u32 v21, v102, v103
    v_add_u32 v22, 0x10000, v20
    v_add_u32 v23, 0x10000, v21
    v_add_u32 v24, 148992, v20
    v_add_u32 v25, 148992, v21
    s_lshr_b32 s58, s47, 1
    s_lshl_b32 s58, s58, 2
    s_and_b32 s59, s47, 1
    s_lshl_b32 s59, s59, 1
    s_add_u32 s58, s58, s59
    s_add_u32 s58, s58, s33
    s_lshl_b32 s58, s58, 7
    s_add_u32 s58, s58, 12591104
    v_lshlrev_b32 v102, 3, v1
    v_add_u32 v26, s58, v102
    s_lshr_b32 s58, s47, 4
    s_lshl_b32 s58, s58, 9
    s_lshl_b32 s59, s48, 6
    s_add_u32 s58, s58, s59
    s_lshl_b32 s58, s58, 3
    s_add_u32 s58, s58, 12599296
    v_add_u32 v27, s58, v102
    s_lshl_b32 s58, s4, 12
    v_add_u32 v28, s58, v2
    s_xor_b32 s58, s4, 2
    s_lshl_b32 s58, s58, 12
    v_add_u32 v29, s58, v2
    v_lshrrev_b32 v102, 3, v0
    v_and_b32 v103, 7, v0
    v_lshlrev_b32 v103, 4, v103
    v_lshlrev_b32 v30, 12, v102
    v_add_u32 v30, v30, v103
    v_mul_u32_u24 v31, 144, v102
    v_add_u32 v31, v31, v103
    v_add_u32 v31, 133632, v31
    v_lshlrev_b32 v102, 2, v4
    v_bfe_u32 v103, v1, 2, 2
    v_add_u32 v102, v102, v103
    s_lshl_b32 s58, s32, 5
    v_add_u32 v102, s58, v102
    v_mul_u32_u24 v102, 144, v102
    v_bfe_u32 v103, v1, 4, 1
    v_lshlrev_b32 v103, 5, v103
    v_add_u32 v102, v102, v103
    v_and_b32 v103, 3, v1
    v_lshlrev_b32 v103, 3, v103
    v_add_u32 v102, v102, v103
    s_lshl_b32 s58, s33, 6
    s_add_u32 s58, s58, 133632
    v_add_u32 v32, s58, v102
    v_lshlrev_b32 v102, 10, v3
    v_lshlrev_b32 v103, 3, v4
    v_add_u32 v33, v102, v103
    v_add_u32 v18, 20480, v18
    s_lshl_b32 s52, s4, 1
    s_mul_i32 s53, s52, 1056
    s_add_u32 s53, s53, 98304
    s_mul_i32 s54, s52, 1088
    s_add_u32 s54, s54, 106752
    v_add_u32 v126, s53, v2
    v_add_u32 v127, s54, v2
    s_waitcnt vmcnt(12)
    v_lshlrev_b32 v102, 16, v34
    v_and_b32 v103, 0xffff0000, v34
    v_lshlrev_b32 v104, 16, v35
    v_and_b32 v105, 0xffff0000, v35
    v_lshlrev_b32 v106, 16, v36
    v_and_b32 v107, 0xffff0000, v36
    v_lshlrev_b32 v108, 16, v37
    v_and_b32 v109, 0xffff0000, v37
    s_waitcnt vmcnt(11)
    v_lshlrev_b32 v110, 16, v38
    v_and_b32 v111, 0xffff0000, v38
    v_lshlrev_b32 v112, 16, v39
    v_and_b32 v113, 0xffff0000, v39
    v_lshlrev_b32 v114, 16, v40
    v_and_b32 v115, 0xffff0000, v40
    v_lshlrev_b32 v116, 16, v41
    v_and_b32 v117, 0xffff0000, v41
    v_readlane_b32 s52, v102, 0
    v_readlane_b32 s54, v110, 0
    s_mov_b32 s53, s52
    s_mov_b32 s55, s54
    v_pk_add_f32 v[102:103], v[102:103], s[52:53] neg_lo:[0,1] neg_hi:[0,1]
    v_pk_add_f32 v[104:105], v[104:105], s[52:53] neg_lo:[0,1] neg_hi:[0,1]
    v_pk_add_f32 v[106:107], v[106:107], s[52:53] neg_lo:[0,1] neg_hi:[0,1]
    v_pk_add_f32 v[108:109], v[108:109], s[52:53] neg_lo:[0,1] neg_hi:[0,1]
    v_pk_add_f32 v[110:111], v[110:111], s[54:55] neg_lo:[0,1] neg_hi:[0,1]
    v_pk_add_f32 v[112:113], v[112:113], s[54:55] neg_lo:[0,1] neg_hi:[0,1]
    v_pk_add_f32 v[114:115], v[114:115], s[54:55] neg_lo:[0,1] neg_hi:[0,1]
    v_pk_add_f32 v[116:117], v[116:117], s[54:55] neg_lo:[0,1] neg_hi:[0,1]
    v_pk_add_f32 v[118:119], v[102:103], v[104:105]
    v_pk_add_f32 v[120:121], v[106:107], v[108:109]
    v_pk_add_f32 v[122:123], v[110:111], v[112:113]
    v_pk_add_f32 v[124:125], v[114:115], v[116:117]
    v_pk_add_f32 v[118:119], v[118:119], v[120:121]
    v_pk_add_f32 v[122:123], v[122:123], v[124:125]
    v_add_f32 v62, v118, v119
    v_add_f32 v63, v122, v123
    v_pk_mul_f32 v[118:119], v[102:103], v[102:103]
    v_pk_mul_f32 v[122:123], v[110:111], v[110:111]
    v_pk_fma_f32 v[118:119], v[104:105], v[104:105], v[118:119]
    v_pk_fma_f32 v[122:123], v[112:113], v[112:113], v[122:123]
    v_pk_fma_f32 v[118:119], v[106:107], v[106:107], v[118:119]
    v_pk_fma_f32 v[122:123], v[114:115], v[114:115], v[122:123]
    v_pk_fma_f32 v[118:119], v[108:109], v[108:109], v[118:119]
    v_pk_fma_f32 v[122:123], v[116:117], v[116:117], v[122:123]
    v_add_f32 v68, v118, v119
    v_add_f32 v69, v122, v123
    v_add_f32_dpp v62, v62, v62 row_shr:1 row_mask:0xf bank_mask:0xf bound_ctrl:1
    v_add_f32_dpp v63, v63, v63 row_shr:1 row_mask:0xf bank_mask:0xf bound_ctrl:1
    v_add_f32_dpp v68, v68, v68 row_shr:1 row_mask:0xf bank_mask:0xf bound_ctrl:1
    v_add_f32_dpp v69, v69, v69 row_shr:1 row_mask:0xf bank_mask:0xf bound_ctrl:1
    v_add_f32_dpp v62, v62, v62 row_shr:2 row_mask:0xf bank_mask:0xf bound_ctrl:1
    v_add_f32_dpp v63, v63, v63 row_shr:2 row_mask:0xf bank_mask:0xf bound_ctrl:1
    v_add_f32_dpp v68, v68, v68 row_shr:2 row_mask:0xf bank_mask:0xf bound_ctrl:1
    v_add_f32_dpp v69, v69, v69 row_shr:2 row_mask:0xf bank_mask:0xf bound_ctrl:1
    v_add_f32_dpp v62, v62, v62 row_shr:4 row_mask:0xf bank_mask:0xf bound_ctrl:1
    v_add_f32_dpp v63, v63, v63 row_shr:4 row_mask:0xf bank_mask:0xf bound_ctrl:1
    v_add_f32_dpp v68, v68, v68 row_shr:4 row_mask:0xf bank_mask:0xf bound_ctrl:1
    v_add_f32_dpp v69, v69, v69 row_shr:4 row_mask:0xf bank_mask:0xf bound_ctrl:1
    v_add_f32_dpp v62, v62, v62 row_shr:8 row_mask:0xf bank_mask:0xf bound_ctrl:1
    v_add_f32_dpp v63, v63, v63 row_shr:8 row_mask:0xf bank_mask:0xf bound_ctrl:1
    v_add_f32_dpp v68, v68, v68 row_shr:8 row_mask:0xf bank_mask:0xf bound_ctrl:1
    v_add_f32_dpp v69, v69, v69 row_shr:8 row_mask:0xf bank_mask:0xf bound_ctrl:1
    v_add_f32_dpp v62, v62, v62 row_bcast:15 row_mask:0xa bank_mask:0xf
    v_add_f32_dpp v63, v63, v63 row_bcast:15 row_mask:0xa bank_mask:0xf
    v_add_f32_dpp v68, v68, v68 row_bcast:15 row_mask:0xa bank_mask:0xf
    v_add_f32_dpp v69, v69, v69 row_bcast:15 row_mask:0xa bank_mask:0xf
    v_add_f32_dpp v62, v62, v62 row_bcast:31 row_mask:0xc bank_mask:0xf
    v_add_f32_dpp v63, v63, v63 row_bcast:31 row_mask:0xc bank_mask:0xf
    v_add_f32_dpp v68, v68, v68 row_bcast:31 row_mask:0xc bank_mask:0xf
    v_add_f32_dpp v69, v69, v69 row_bcast:31 row_mask:0xc bank_mask:0xf
    v_readlane_b32 s56, v62, 63
    v_readlane_b32 s57, v63, 63
    v_readlane_b32 s58, v68, 63
    v_readlane_b32 s59, v69, 63
    s_mov_b32 s60, 0x3b000000
    v_mov_b32 v118, s56
    v_mov_b32 v120, s58
    v_mov_b32 v119, s57
    v_mov_b32 v121, s59
    v_pk_mul_f32 v[118:119], v[118:119], s[60:61] op_sel_hi:[1,0]
    v_pk_mul_f32 v[120:121], v[120:121], s[60:61] op_sel_hi:[1,0]
    v_pk_fma_f32 v[120:121], v[118:119], v[118:119], v[120:121] neg_lo:[1,0,0] neg_hi:[1,0,0]
    v_add_f32 v122, s52, v118
    v_add_f32 v123, s54, v119
    v_max_f32 v120, 0, v120
    v_max_f32 v121, 0, v121
    v_cvt_pk_bf16_f32 v122, v122, v123
    v_cvt_pk_bf16_f32 v123, v120, v121
    s_mov_b32 s60, 0x3727c5ac
    v_lshlrev_b32 v120, 16, v123
    v_and_b32 v121, 0xffff0000, v123
    v_lshlrev_b32 v118, 16, v122
    v_pk_add_f32 v[120:121], v[120:121], s[60:61] op_sel_hi:[1,0]
    v_and_b32 v119, 0xffff0000, v122
    v_cvt_pk_bf16_f32 v123, v120, v121
    v_sub_f32 v118, s52, v118
    v_lshlrev_b32 v120, 16, v123
    v_and_b32 v121, 0xffff0000, v123
    v_sqrt_f32 v120, v120
    v_sqrt_f32 v121, v121
    v_sub_f32 v119, s54, v119
    v_cvt_pk_bf16_f32 v123, v120, v121
    v_lshlrev_b32 v120, 16, v123
    v_and_b32 v121, 0xffff0000, v123
    v_rcp_f32 v120, v120
    v_rcp_f32 v121, v121
    s_nop 0
    v_pk_mul_f32 v[118:119], v[118:119], v[120:121]
    v_pk_fma_f32 v[102:103], v[102:103], v[120:121], v[118:119] op_sel:[0,0,0] op_sel_hi:[1,0,0]
    v_pk_fma_f32 v[104:105], v[104:105], v[120:121], v[118:119] op_sel:[0,0,0] op_sel_hi:[1,0,0]
    v_pk_fma_f32 v[106:107], v[106:107], v[120:121], v[118:119] op_sel:[0,0,0] op_sel_hi:[1,0,0]
    v_pk_fma_f32 v[108:109], v[108:109], v[120:121], v[118:119] op_sel:[0,0,0] op_sel_hi:[1,0,0]
    v_pk_fma_f32 v[110:111], v[110:111], v[120:121], v[118:119] op_sel:[0,1,1] op_sel_hi:[1,1,1]
    v_pk_fma_f32 v[112:113], v[112:113], v[120:121], v[118:119] op_sel:[0,1,1] op_sel_hi:[1,1,1]
    v_pk_fma_f32 v[114:115], v[114:115], v[120:121], v[118:119] op_sel:[0,1,1] op_sel_hi:[1,1,1]
    v_pk_fma_f32 v[116:117], v[116:117], v[120:121], v[118:119] op_sel:[0,1,1] op_sel_hi:[1,1,1]
    v_cvt_pk_bf16_f32 v34, v102, v103
    v_cvt_pk_bf16_f32 v35, v104, v105
    v_cvt_pk_bf16_f32 v36, v106, v107
    v_cvt_pk_bf16_f32 v37, v108, v109
    ds_write_b128 v126, v[34:37] offset:0
    v_cvt_pk_bf16_f32 v38, v110, v111
    v_cvt_pk_bf16_f32 v39, v112, v113
    v_cvt_pk_bf16_f32 v40, v114, v115
    v_cvt_pk_bf16_f32 v41, v116, v117
    ds_write_b128 v126, v[38:41] offset:1056
    v_cvt_pk_f16_f32 v118, v102, v103
    v_cvt_pk_f16_f32 v119, v104, v105
    v_cvt_pk_f16_f32 v120, v106, v107
    v_cvt_pk_f16_f32 v121, v108, v109
    ds_write_b128 v127, v[118:121] offset:0
    v_cvt_pk_f16_f32 v122, v110, v111
    v_cvt_pk_f16_f32 v123, v112, v113
    v_cvt_pk_f16_f32 v124, v114, v115
    v_cvt_pk_f16_f32 v125, v116, v117
    ds_write_b128 v127, v[122:125] offset:1088
    s_cmp_lg_u32 s4, 1
    s_cbranch_scc1 L_bl_4
    s_waitcnt vmcnt(7)
    v_lshlrev_b32 v128, 16, v51
    s_waitcnt vmcnt(6)
    v_lshlrev_b32 v129, 16, v52
    v_lshlrev_b32 v130, 2, v1
    v_add_u32 v130, 162240, v130
    ds_write_b32 v130, v128
    s_mov_b32 exec_hi, 0
    ds_write_b32 v130, v129 offset:256
    s_mov_b32 exec_hi, -1
L_bl_4:
    s_waitcnt lgkmcnt(0)
    s_barrier
    s_cmp_ge_u32 s4, 2
    s_cbranch_scc1 L_ln1_5
    v_and_b32 v34, 7, v0
    v_lshrrev_b32 v35, 3, v0
    v_mul_u32_u24 v36, 1056, v34
    v_lshlrev_b32 v37, 4, v35
    v_add_u32 v36, v36, v37
    v_add_u32 v36, 98304, v36
    ds_read_b128 v[102:105], v36 offset:0
    ds_read_b128 v[106:109], v36 offset:256
    ds_read_b128 v[110:113], v36 offset:512
    ds_read_b128 v[114:117], v36 offset:768
    v_lshrrev_b32 v37, 1, v35
    v_lshlrev_b32 v37, 10, v37
    v_and_b32 v35, 1, v35
    v_lshlrev_b32 v35, 9, v35
    v_add_u32 v37, v37, v35
    v_lshlrev_b32 v34, 4, v34
    v_add_u32 v37, v37, v34
    s_lshr_b32 s52, s3, 2
    s_lshl_b32 s52, s52, 15
    s_and_b32 s53, s3, 3
    s_lshl_b32 s53, s53, 7
    s_add_u32 s52, s52, s53
    s_add_u32 s52, s52, 0
    s_waitcnt lgkmcnt(3)
    buffer_store_dwordx4 v[102:105], v37, s[20:23], s52 offen sc1
    s_add_u32 s52, s52, 8192
    s_waitcnt lgkmcnt(2)
    buffer_store_dwordx4 v[106:109], v37, s[20:23], s52 offen sc1
    s_add_u32 s52, s52, 8192
    s_waitcnt lgkmcnt(1)
    buffer_store_dwordx4 v[110:113], v37, s[20:23], s52 offen sc1
    s_add_u32 s52, s52, 8192
    s_waitcnt lgkmcnt(0)
    buffer_store_dwordx4 v[114:117], v37, s[20:23], s52 offen sc1
    s_branch L_ln2_6
L_ln1_5:
    v_bfe_u32 v34, v1, 2, 2
    v_mul_u32_u24 v34, 1088, v34
    v_lshrrev_b32 v35, 4, v1
    v_lshlrev_b32 v35, 5, v35
    v_add_u32 v34, v34, v35
    v_and_b32 v35, 3, v1
    v_lshlrev_b32 v35, 3, v35
    v_add_u32 v34, v34, v35
    s_lshl_b32 s52, s33, 9
    s_add_u32 s52, s52, 106752
    v_add_u32 v34, s52, v34
    ds_read_b64_tr_b16 v[102:103], v34 offset:0
    ds_read_b64_tr_b16 v[104:105], v34 offset:4352
    ds_read_b64_tr_b16 v[106:107], v34 offset:128
    ds_read_b64_tr_b16 v[108:109], v34 offset:4480
    ds_read_b64_tr_b16 v[110:111], v34 offset:256
    ds_read_b64_tr_b16 v[112:113], v34 offset:4608
    ds_read_b64_tr_b16 v[114:115], v34 offset:384
    ds_read_b64_tr_b16 v[116:117], v34 offset:4736
    s_lshl_b32 s52, s3, 13
    s_lshl_b32 s53, s33, 12
    s_add_u32 s52, s52, s53
    s_add_u32 s52, s52, 2097152
    s_waitcnt lgkmcnt(6)
    buffer_store_dwordx4 v[102:105], v2, s[20:23], s52 offen offset:0 sc1
    s_waitcnt lgkmcnt(4)
    buffer_store_dwordx4 v[106:109], v2, s[20:23], s52 offen offset:1024 sc1
    s_waitcnt lgkmcnt(2)
    buffer_store_dwordx4 v[110:113], v2, s[20:23], s52 offen offset:2048 sc1
    s_waitcnt lgkmcnt(0)
    buffer_store_dwordx4 v[114:117], v2, s[20:23], s52 offen offset:3072 sc1
L_ln2_6:
    s_waitcnt vmcnt(10)
    v_add_u32 v50, 1, v50
    s_nop 0
    v_readfirstlane_b32 s46, v50
    s_mov_b32 m0, s97
    s_nop 0
    buffer_load_dwordx4 v56, s[12:15], s96 offen offset:0 lds
    s_lshl_b32 s53, s49, 16
    s_and_b32 s54, s49, 0xffff0000
    s_lshl_b32 s56, s50, 16
    s_and_b32 s55, s50, 0xffff0000
    s_cmp_eq_u32 s32, 0
    s_cselect_b32 s53, s53, s54
    s_cselect_b32 s45, s56, s55
    s_cmp_eq_u32 s33, 0
    s_cselect_b32 s57, 16, 0
    v_mov_b32 v34, s53
    v_mul_f32 v34, 0x3fb8aa3b, v34
    v_lshlrev_b32 v35, s57, v46
    v_and_b32 v35, 0xffff0000, v35
    v_mul_f32 v35, 0x3fb8aa3b, v35
    v_exp_f32 v34, v34
    v_exp_f32 v35, v35
    v_and_b32 v36, 0x7fff7fff, v48
    v_and_b32 v37, 0x7fff7fff, v49
    v_pk_max_u16 v36, v36, v37
    v_cvt_pk_bf16_f32 v34, v34, v35
    v_lshrrev_b32 v37, 16, v36
    v_and_b32 v36, 0xffff, v36
    buffer_load_dwordx4 v57, s[12:15], s96 offen offset:1024 lds
    v_max_u32 v36, v36, v37
    v_and_b32 v35, 0xffff0000, v34
    v_lshlrev_b32 v34, 16, v34
    v_lshlrev_b32 v47, s57, v47
    v_lshlrev_b32 v48, s57, v48
    v_lshlrev_b32 v49, s57, v49
    v_max_u32_dpp v36, v36, v36 row_shr:1 row_mask:0xf bank_mask:0xf bound_ctrl:1
    v_mul_f32 v37, v35, v34
    v_and_b32 v38, 0xffff0000, v47
    v_max_u32_dpp v36, v36, v36 row_shr:2 row_mask:0xf bank_mask:0xf bound_ctrl:1
    v_mul_f32 v38, v38, v34
    v_mul_f32 v37, 0xbfb8aa3b, v37
    v_max_u32_dpp v36, v36, v36 row_shr:4 row_mask:0xf bank_mask:0xf bound_ctrl:1
    v_mul_f32 v38, 0x3e22f983, v38
    v_mul_f32 v39, 0x43800000, v37
    v_max_u32_dpp v36, v36, v36 row_shr:8 row_mask:0xf bank_mask:0xf bound_ctrl:1
    v_mul_f32 v40, 0x43800000, v38
    v_fract_f32 v41, v38
    v_max_u32_dpp v36, v36, v36 row_bcast:15 row_mask:0xa bank_mask:0xf
    v_fract_f32 v40, v40
    v_exp_f32 v37, v37
    buffer_load_dwordx4 v58, s[12:15], s96 offen offset:2048 lds
    s_add_u32 s96, s96, 44032
    s_add_u32 s97, s97, 3072
    v_max_u32_dpp v36, v36, v36 row_bcast:31 row_mask:0xc bank_mask:0xf
    v_exp_f32 v39, v39
    v_cos_f32 v50, v41
    v_sin_f32 v51, v41
    v_readlane_b32 s52, v36, 63
    v_cos_f32 v62, v40
    v_sin_f32 v63, v40
    s_and_b32 s52, s52, 0x7f80
    s_lshl_b32 s52, s52, 16
    s_sub_u32 s53, 0x7f000000, s52
    v_and_b32 v68, 0xffff0000, v48
    v_and_b32 v69, 0xffff0000, v49
    v_mul_f32 v34, s52, v34
    v_mul_f32 v68, s53, v68
    v_mul_f32 v69, s53, v69
    v_add_f32 v34, v34, v34
    v_mul_f32 v50, v50, v37
    v_mul_f32 v51, v51, v37
    v_readfirstlane_b32 s44, v34
    v_mul_f32 v62, v62, v39
    v_mul_f32 v63, v63, v39
    s_barrier
    s_mov_b32 m0, s97
    s_nop 0
    buffer_load_dwordx4 v56, s[12:15], s96 offen offset:0 lds
    v_cvt_pk_f16_f32 v102, v68, v69
    v_pk_mul_f32 v[34:35], v[50:51], v[50:51] op_sel:[0,0] op_sel_hi:[0,1]
    v_pk_fma_f32 v[34:35], v[50:51], v[50:51], v[34:35] op_sel:[1,1,0] op_sel_hi:[1,0,1] neg_lo:[1,0,0]
    v_pk_mul_f32 v[126:127], v[68:69], v[50:51] op_sel:[0,0] op_sel_hi:[0,1]
    v_pk_mul_f32 v[130:131], v[68:69], v[62:63] op_sel:[0,0] op_sel_hi:[0,1]
    v_pk_mul_f32 v[36:37], v[34:35], v[34:35] op_sel:[0,0] op_sel_hi:[0,1]
    v_pk_fma_f32 v[126:127], v[68:69], v[50:51], v[126:127] op_sel:[1,1,0] op_sel_hi:[1,0,1] neg_lo:[1,0,0]
    v_pk_fma_f32 v[130:131], v[68:69], v[62:63], v[130:131] op_sel:[1,1,0] op_sel_hi:[1,0,1] neg_lo:[1,0,0]
    v_pk_fma_f32 v[36:37], v[34:35], v[34:35], v[36:37] op_sel:[1,1,0] op_sel_hi:[1,0,1] neg_lo:[1,0,0]
    v_cvt_pk_f16_f32 v103, v126, v127
    ds_write2_b32 v70, v102, v103 offset0:0 offset1:68
    v_cvt_pk_f16_f32 v104, v130, v131
    v_pk_mul_f32 v[128:129], v[126:127], v[50:51] op_sel:[0,0] op_sel_hi:[0,1]
    v_pk_mul_f32 v[132:133], v[130:131], v[62:63] op_sel:[0,0] op_sel_hi:[0,1]
    v_pk_mul_f32 v[38:39], v[36:37], v[36:37] op_sel:[0,0] op_sel_hi:[0,1]
    v_pk_mul_f32 v[134:135], v[130:131], v[34:35] op_sel:[0,0] op_sel_hi:[0,1]
    v_pk_fma_f32 v[128:129], v[126:127], v[50:51], v[128:129] op_sel:[1,1,0] op_sel_hi:[1,0,1] neg_lo:[1,0,0]
    buffer_load_dwordx4 v57, s[12:15], s96 offen offset:1024 lds
    v_pk_fma_f32 v[132:133], v[130:131], v[62:63], v[132:133] op_sel:[1,1,0] op_sel_hi:[1,0,1] neg_lo:[1,0,0]
    v_pk_fma_f32 v[38:39], v[36:37], v[36:37], v[38:39] op_sel:[1,1,0] op_sel_hi:[1,0,1] neg_lo:[1,0,0]
    v_pk_fma_f32 v[134:135], v[130:131], v[34:35], v[134:135] op_sel:[1,1,0] op_sel_hi:[1,0,1] neg_lo:[1,0,0]
    v_cvt_pk_f16_f32 v105, v128, v129
    v_cvt_pk_f16_f32 v106, v132, v133
    v_cvt_pk_f16_f32 v107, v134, v135
    ds_write2_b32 v72, v104, v107 offset0:0 offset1:68
    v_pk_mul_f32 v[126:127], v[128:129], v[50:51] op_sel:[0,0] op_sel_hi:[0,1]
    v_pk_mul_f32 v[130:131], v[132:133], v[62:63] op_sel:[0,0] op_sel_hi:[0,1]
    v_pk_mul_f32 v[40:41], v[38:39], v[38:39] op_sel:[0,0] op_sel_hi:[0,1]
    v_pk_mul_f32 v[136:137], v[134:135], v[34:35] op_sel:[0,0] op_sel_hi:[0,1]
    v_pk_mul_f32 v[138:139], v[132:133], v[36:37] op_sel:[0,0] op_sel_hi:[0,1]
    v_pk_fma_f32 v[126:127], v[128:129], v[50:51], v[126:127] op_sel:[1,1,0] op_sel_hi:[1,0,1] neg_lo:[1,0,0]
    v_pk_fma_f32 v[130:131], v[132:133], v[62:63], v[130:131] op_sel:[1,1,0] op_sel_hi:[1,0,1] neg_lo:[1,0,0]
    v_pk_fma_f32 v[40:41], v[38:39], v[38:39], v[40:41] op_sel:[1,1,0] op_sel_hi:[1,0,1] neg_lo:[1,0,0]
    v_pk_fma_f32 v[136:137], v[134:135], v[34:35], v[136:137] op_sel:[1,1,0] op_sel_hi:[1,0,1] neg_lo:[1,0,0]
    v_pk_fma_f32 v[138:139], v[132:133], v[36:37], v[138:139] op_sel:[1,1,0] op_sel_hi:[1,0,1] neg_lo:[1,0,0]
    buffer_load_dwordx4 v58, s[12:15], s96 offen offset:2048 lds
    s_add_u32 s96, s96, 44032
    s_add_u32 s97, s97, 3072
    v_cvt_pk_f16_f32 v108, v126, v127
    ds_write2_b32 v70, v105, v108 offset0:136 offset1:204
    v_cvt_pk_f16_f32 v109, v130, v131
    v_cvt_pk_f16_f32 v110, v136, v137
    v_cvt_pk_f16_f32 v111, v138, v139
    v_pk_mul_f32 v[128:129], v[126:127], v[50:51] op_sel:[0,0] op_sel_hi:[0,1]
    v_pk_mul_f32 v[132:133], v[130:131], v[62:63] op_sel:[0,0] op_sel_hi:[0,1]
    ds_write2_b32 v73, v106, v111 offset0:0 offset1:68
    v_pk_mul_f32 v[46:47], v[40:41], v[40:41] op_sel:[0,0] op_sel_hi:[0,1]
    v_pk_mul_f32 v[134:135], v[136:137], v[34:35] op_sel:[0,0] op_sel_hi:[0,1]
    v_pk_mul_f32 v[138:139], v[130:131], v[36:37] op_sel:[0,0] op_sel_hi:[0,1]
    v_pk_mul_f32 v[140:141], v[40:41], v[38:39] op_sel:[0,0] op_sel_hi:[0,1]
    v_pk_fma_f32 v[128:129], v[126:127], v[50:51], v[128:129] op_sel:[1,1,0] op_sel_hi:[1,0,1] neg_lo:[1,0,0]
    v_pk_fma_f32 v[132:133], v[130:131], v[62:63], v[132:133] op_sel:[1,1,0] op_sel_hi:[1,0,1] neg_lo:[1,0,0]
    v_pk_fma_f32 v[46:47], v[40:41], v[40:41], v[46:47] op_sel:[1,1,0] op_sel_hi:[1,0,1] neg_lo:[1,0,0]
    v_pk_fma_f32 v[134:135], v[136:137], v[34:35], v[134:135] op_sel:[1,1,0] op_sel_hi:[1,0,1] neg_lo:[1,0,0]
    s_mov_b32 m0, s97
    s_nop 0
    buffer_load_dwordx4 v56, s[12:15], s96 offen offset:0 lds
    v_pk_fma_f32 v[138:139], v[130:131], v[36:37], v[138:139] op_sel:[1,1,0] op_sel_hi:[1,0,1] neg_lo:[1,0,0]
    v_pk_fma_f32 v[140:141], v[40:41], v[38:39], v[140:141] op_sel:[1,1,0] op_sel_hi:[1,0,1] neg_lo:[1,0,0]
    v_cvt_pk_f16_f32 v112, v128, v129
    v_cvt_pk_f16_f32 v113, v132, v133
    v_cvt_pk_f16_f32 v114, v134, v135
    ds_write2_b32 v72, v110, v114 offset0:136 offset1:204
    v_cvt_pk_f16_f32 v115, v138, v139
    v_mov_b32 v116, 0x3c00
    v_cvt_pk_f16_f32 v117, v38, -v39
    v_cvt_pk_f16_f32 v118, v40, -v41
    v_cvt_pk_f16_f32 v119, v140, -v141
    ds_write2_b32 v73, v109, v115 offset0:136 offset1:204
    v_pk_mul_f32 v[126:127], v[128:129], v[50:51] op_sel:[0,0] op_sel_hi:[0,1]
    v_pk_mul_f32 v[130:131], v[132:133], v[62:63] op_sel:[0,0] op_sel_hi:[0,1]
    v_pk_fma_f32 v[126:127], v[128:129], v[50:51], v[126:127] op_sel:[1,1,0] op_sel_hi:[1,0,1] neg_lo:[1,0,0]
    v_pk_fma_f32 v[130:131], v[132:133], v[62:63], v[130:131] op_sel:[1,1,0] op_sel_hi:[1,0,1] neg_lo:[1,0,0]
    v_cvt_pk_f16_f32 v120, v126, v127
    buffer_load_dwordx4 v57, s[12:15], s96 offen offset:1024 lds
    ds_write2_b32 v76, v116, v117 offset0:0 offset1:68
    v_cvt_pk_f16_f32 v121, v130, v131
    v_pk_mul_f32 v[128:129], v[126:127], v[50:51] op_sel:[0,0] op_sel_hi:[0,1]
    v_pk_mul_f32 v[132:133], v[130:131], v[62:63] op_sel:[0,0] op_sel_hi:[0,1]
    v_pk_fma_f32 v[128:129], v[126:127], v[50:51], v[128:129] op_sel:[1,1,0] op_sel_hi:[1,0,1] neg_lo:[1,0,0]
    v_pk_fma_f32 v[132:133], v[130:131], v[62:63], v[132:133] op_sel:[1,1,0] op_sel_hi:[1,0,1] neg_lo:[1,0,0]
    ds_write2_b32 v76, v118, v119 offset0:136 offset1:204
    v_cvt_pk_f16_f32 v122, v128, v129
    v_cvt_pk_f16_f32 v123, v132, v133
    v_pk_mul_f32 v[126:127], v[128:129], v[50:51] op_sel:[0,0] op_sel_hi:[0,1]
    v_pk_mul_f32 v[130:131], v[132:133], v[62:63] op_sel:[0,0] op_sel_hi:[0,1]
    v_pk_fma_f32 v[126:127], v[128:129], v[50:51], v[126:127] op_sel:[1,1,0] op_sel_hi:[1,0,1] neg_lo:[1,0,0]
    ds_write2_b32 v71, v112, v120 offset0:0 offset1:68
    v_pk_fma_f32 v[130:131], v[132:133], v[62:63], v[130:131] op_sel:[1,1,0] op_sel_hi:[1,0,1] neg_lo:[1,0,0]
    v_cvt_pk_f16_f32 v124, v126, v127
    v_cvt_pk_f16_f32 v125, v130, v131
    s_waitcnt vmcnt(8)
    s_lshl_b32 s101, s3, 4
    s_lshl_b32 s100, s33, 3
    s_add_u32 s101, s101, s100
    s_lshl_b32 s100, s32, 12
    s_mul_i32 s100, s100, 5
    s_add_u32 s101, s101, s100
    s_add_u32 s100, s101, 12587008
    v_mov_b32 v48, s100
    v_mov_b32 v49, s46
    s_mov_b64 exec, 1
    buffer_store_dword v49, v48, s[20:23], 0 offen sc1
    s_mov_b64 exec, -1
    buffer_load_dwordx4 v58, s[12:15], s96 offen offset:2048 lds
    s_add_u32 s96, s96, 44032
    s_add_u32 s97, s97, 3072
    v_pk_mul_f32 v[132:133], v[130:131], v[62:63] op_sel:[0,0] op_sel_hi:[0,1]
    v_pk_fma_f32 v[132:133], v[130:131], v[62:63], v[132:133] op_sel:[1,1,0] op_sel_hi:[1,0,1] neg_lo:[1,0,0]
    ds_write2_b32 v74, v113, v121 offset0:0 offset1:68
    v_cvt_pk_f16_f32 v102, v132, v133
    v_pk_mul_f32 v[128:129], v[38:39], v[46:47] op_sel:[0,0] op_sel_hi:[0,1]
    v_pk_mul_f32 v[130:131], v[40:41], v[46:47] op_sel:[0,0] op_sel_hi:[0,1]
    v_pk_mul_f32 v[132:133], v[140:141], v[46:47] op_sel:[0,0] op_sel_hi:[0,1]
    v_pk_fma_f32 v[128:129], v[38:39], v[46:47], v[128:129] op_sel:[1,1,0] op_sel_hi:[1,0,1] neg_lo:[1,0,0]
    ds_write2_b32 v71, v122, v124 offset0:136 offset1:204
    v_pk_fma_f32 v[130:131], v[40:41], v[46:47], v[130:131] op_sel:[1,1,0] op_sel_hi:[1,0,1] neg_lo:[1,0,0]
    v_pk_fma_f32 v[132:133], v[140:141], v[46:47], v[132:133] op_sel:[1,1,0] op_sel_hi:[1,0,1] neg_lo:[1,0,0]
    v_cvt_pk_f16_f32 v103, v46, -v47
    v_cvt_pk_f16_f32 v104, v128, -v129
    v_cvt_pk_f16_f32 v105, v130, -v131
    ds_write2_b32 v74, v123, v125 offset0:136 offset1:204
    v_cvt_pk_f16_f32 v106, v132, -v133
    v_pk_mul_f32 v[134:135], v[46:47], v[46:47] op_sel:[0,0] op_sel_hi:[0,1]
    v_pk_mul_f32 v[136:137], v[128:129], v[46:47] op_sel:[0,0] op_sel_hi:[0,1]
    v_pk_mul_f32 v[138:139], v[130:131], v[46:47] op_sel:[0,0] op_sel_hi:[0,1]
    v_pk_mul_f32 v[50:51], v[132:133], v[46:47] op_sel:[0,0] op_sel_hi:[0,1]
    ds_write_b32 v75, v102 offset:0
    s_mov_b32 m0, s97
    s_nop 0
    buffer_load_dwordx4 v56, s[12:15], s96 offen offset:0 lds
    v_pk_fma_f32 v[134:135], v[46:47], v[46:47], v[134:135] op_sel:[1,1,0] op_sel_hi:[1,0,1] neg_lo:[1,0,0]
    v_pk_fma_f32 v[136:137], v[128:129], v[46:47], v[136:137] op_sel:[1,1,0] op_sel_hi:[1,0,1] neg_lo:[1,0,0]
    v_pk_fma_f32 v[138:139], v[130:131], v[46:47], v[138:139] op_sel:[1,1,0] op_sel_hi:[1,0,1] neg_lo:[1,0,0]
    v_pk_fma_f32 v[50:51], v[132:133], v[46:47], v[50:51] op_sel:[1,1,0] op_sel_hi:[1,0,1] neg_lo:[1,0,0]
    v_cvt_pk_f16_f32 v107, v134, -v135
    ds_write2_b32 v77, v103, v104 offset0:0 offset1:68
    v_cvt_pk_f16_f32 v108, v136, -v137
    v_cvt_pk_f16_f32 v109, v138, -v139
    v_cvt_pk_f16_f32 v110, v50, -v51
    v_pk_mul_f32 v[126:127], v[134:135], v[46:47] op_sel:[0,0] op_sel_hi:[0,1]
    v_pk_mul_f32 v[128:129], v[136:137], v[46:47] op_sel:[0,0] op_sel_hi:[0,1]
    ds_write2_b32 v77, v105, v106 offset0:136 offset1:204
    v_pk_mul_f32 v[130:131], v[138:139], v[46:47] op_sel:[0,0] op_sel_hi:[0,1]
    v_pk_mul_f32 v[132:133], v[50:51], v[46:47] op_sel:[0,0] op_sel_hi:[0,1]
    v_pk_fma_f32 v[126:127], v[134:135], v[46:47], v[126:127] op_sel:[1,1,0] op_sel_hi:[1,0,1] neg_lo:[1,0,0]
    v_pk_fma_f32 v[128:129], v[136:137], v[46:47], v[128:129] op_sel:[1,1,0] op_sel_hi:[1,0,1] neg_lo:[1,0,0]
    v_pk_fma_f32 v[130:131], v[138:139], v[46:47], v[130:131] op_sel:[1,1,0] op_sel_hi:[1,0,1] neg_lo:[1,0,0]
    ds_write2_b32 v78, v107, v108 offset0:0 offset1:68
    v_pk_fma_f32 v[132:133], v[50:51], v[46:47], v[132:133] op_sel:[1,1,0] op_sel_hi:[1,0,1] neg_lo:[1,0,0]
    v_cvt_pk_f16_f32 v111, v126, -v127
    v_cvt_pk_f16_f32 v112, v128, -v129
    buffer_load_dwordx4 v57, s[12:15], s96 offen offset:1024 lds
    v_cvt_pk_f16_f32 v113, v130, -v131
    v_cvt_pk_f16_f32 v114, v132, -v133
    ds_write2_b32 v78, v109, v110 offset0:136 offset1:204
    v_pk_mul_f32 v[134:135], v[126:127], v[46:47] op_sel:[0,0] op_sel_hi:[0,1]
    v_pk_mul_f32 v[136:137], v[128:129], v[46:47] op_sel:[0,0] op_sel_hi:[0,1]
    v_pk_mul_f32 v[138:139], v[130:131], v[46:47] op_sel:[0,0] op_sel_hi:[0,1]
    v_pk_mul_f32 v[50:51], v[132:133], v[46:47] op_sel:[0,0] op_sel_hi:[0,1]
    v_pk_fma_f32 v[134:135], v[126:127], v[46:47], v[134:135] op_sel:[1,1,0] op_sel_hi:[1,0,1] neg_lo:[1,0,0]
    ds_write2_b32 v79, v111, v112 offset0:0 offset1:68
    v_pk_fma_f32 v[136:137], v[128:129], v[46:47], v[136:137] op_sel:[1,1,0] op_sel_hi:[1,0,1] neg_lo:[1,0,0]
    v_pk_fma_f32 v[138:139], v[130:131], v[46:47], v[138:139] op_sel:[1,1,0] op_sel_hi:[1,0,1] neg_lo:[1,0,0]
    v_pk_fma_f32 v[50:51], v[132:133], v[46:47], v[50:51] op_sel:[1,1,0] op_sel_hi:[1,0,1] neg_lo:[1,0,0]
    v_cvt_pk_f16_f32 v115, v134, -v135
    v_cvt_pk_f16_f32 v116, v136, -v137
    ds_write2_b32 v79, v113, v114 offset0:136 offset1:204
    v_cvt_pk_f16_f32 v117, v138, -v139
    v_cvt_pk_f16_f32 v118, v50, -v51
    v_pk_mul_f32 v[126:127], v[134:135], v[46:47] op_sel:[0,0] op_sel_hi:[0,1]
    v_pk_mul_f32 v[128:129], v[136:137], v[46:47] op_sel:[0,0] op_sel_hi:[0,1]
    v_pk_mul_f32 v[130:131], v[138:139], v[46:47] op_sel:[0,0] op_sel_hi:[0,1]
    buffer_load_dwordx4 v58, s[12:15], s96 offen offset:2048 lds
    s_add_u32 s96, s96, 44032
    s_add_u32 s97, s97, 3072
    ds_write2_b32 v80, v115, v116 offset0:0 offset1:68
    v_pk_mul_f32 v[132:133], v[50:51], v[46:47] op_sel:[0,0] op_sel_hi:[0,1]
    v_pk_fma_f32 v[126:127], v[134:135], v[46:47], v[126:127] op_sel:[1,1,0] op_sel_hi:[1,0,1] neg_lo:[1,0,0]
    v_pk_fma_f32 v[128:129], v[136:137], v[46:47], v[128:129] op_sel:[1,1,0] op_sel_hi:[1,0,1] neg_lo:[1,0,0]
    v_pk_fma_f32 v[130:131], v[138:139], v[46:47], v[130:131] op_sel:[1,1,0] op_sel_hi:[1,0,1] neg_lo:[1,0,0]
    v_pk_fma_f32 v[132:133], v[50:51], v[46:47], v[132:133] op_sel:[1,1,0] op_sel_hi:[1,0,1] neg_lo:[1,0,0]
    ds_write2_b32 v80, v117, v118 offset0:136 offset1:204
    v_cvt_pk_f16_f32 v119, v126, -v127
    v_cvt_pk_f16_f32 v120, v128, -v129
    v_cvt_pk_f16_f32 v121, v130, -v131
    v_cvt_pk_f16_f32 v122, v132, -v133
    v_pk_mul_f32 v[134:135], v[126:127], v[46:47] op_sel:[0,0] op_sel_hi:[0,1]
    ds_write2_b32 v81, v119, v120 offset0:0 offset1:68
    v_pk_mul_f32 v[136:137], v[128:129], v[46:47] op_sel:[0,0] op_sel_hi:[0,1]
    v_pk_mul_f32 v[138:139], v[130:131], v[46:47] op_sel:[0,0] op_sel_hi:[0,1]
    v_pk_mul_f32 v[50:51], v[132:133], v[46:47] op_sel:[0,0] op_sel_hi:[0,1]
    v_pk_fma_f32 v[134:135], v[126:127], v[46:47], v[134:135] op_sel:[1,1,0] op_sel_hi:[1,0,1] neg_lo:[1,0,0]
    v_pk_fma_f32 v[136:137], v[128:129], v[46:47], v[136:137] op_sel:[1,1,0] op_sel_hi:[1,0,1] neg_lo:[1,0,0]
    ds_write2_b32 v81, v121, v122 offset0:136 offset1:204
    v_pk_fma_f32 v[138:139], v[130:131], v[46:47], v[138:139] op_sel:[1,1,0] op_sel_hi:[1,0,1] neg_lo:[1,0,0]
    v_pk_fma_f32 v[50:51], v[132:133], v[46:47], v[50:51] op_sel:[1,1,0] op_sel_hi:[1,0,1] neg_lo:[1,0,0]
    s_mov_b32 m0, s97
    s_nop 0
    buffer_load_dwordx4 v56, s[12:15], s96 offen offset:0 lds
    v_cvt_pk_f16_f32 v123, v134, -v135
    v_cvt_pk_f16_f32 v124, v136, -v137
    v_cvt_pk_f16_f32 v125, v138, -v139
    ds_write2_b32 v82, v123, v124 offset0:0 offset1:68
    v_cvt_pk_f16_f32 v102, v50, -v51
    v_pk_mul_f32 v[126:127], v[134:135], v[46:47] op_sel:[0,0] op_sel_hi:[0,1]
    v_pk_mul_f32 v[128:129], v[136:137], v[46:47] op_sel:[0,0] op_sel_hi:[0,1]
    v_pk_mul_f32 v[130:131], v[138:139], v[46:47] op_sel:[0,0] op_sel_hi:[0,1]
    v_pk_mul_f32 v[132:133], v[50:51], v[46:47] op_sel:[0,0] op_sel_hi:[0,1]
    ds_write2_b32 v82, v125, v102 offset0:136 offset1:204
    v_pk_fma_f32 v[126:127], v[134:135], v[46:47], v[126:127] op_sel:[1,1,0] op_sel_hi:[1,0,1] neg_lo:[1,0,0]
    v_pk_fma_f32 v[128:129], v[136:137], v[46:47], v[128:129] op_sel:[1,1,0] op_sel_hi:[1,0,1] neg_lo:[1,0,0]
    v_pk_fma_f32 v[130:131], v[138:139], v[46:47], v[130:131] op_sel:[1,1,0] op_sel_hi:[1,0,1] neg_lo:[1,0,0]
    v_pk_fma_f32 v[132:133], v[50:51], v[46:47], v[132:133] op_sel:[1,1,0] op_sel_hi:[1,0,1] neg_lo:[1,0,0]
    v_cvt_pk_f16_f32 v103, v126, -v127
    v_cvt_pk_f16_f32 v104, v128, -v129
    ds_write2_b32 v83, v103, v104 offset0:0 offset1:68
    v_cvt_pk_f16_f32 v105, v130, -v131
    v_cvt_pk_f16_f32 v106, v132, -v133
    ds_write2_b32 v83, v105, v106 offset0:136 offset1:204
    s_waitcnt lgkmcnt(0)
    s_barrier
    ds_read_b128 v[102:105], v84 offset:0
    ds_read_b128 v[110:113], v85 offset:0
    buffer_load_dwordx4 v57, s[12:15], s96 offen offset:1024 lds
    ds_read_b128 v[106:109], v84 offset:4352
    ds_read_b128 v[114:117], v84 offset:64
    ds_read_b128 v[122:125], v85 offset:64
    ds_read_b128 v[118:121], v84 offset:4416
    ds_read_b128 v[126:129], v84 offset:128
    ds_read_b128 v[134:137], v85 offset:128
    ds_read_b128 v[130:133], v84 offset:4480
    s_waitcnt lgkmcnt(7)
    v_mfma_f32_16x16x32_f16 v[34:37], v[102:105], v[110:113], 0
    buffer_load_dwordx4 v58, s[12:15], s96 offen offset:2048 lds
    s_add_u32 s96, s96, 44032
    s_add_u32 s97, s97, 3072
    s_waitcnt lgkmcnt(6)
    v_mfma_f32_16x16x32_f16 v[38:41], v[106:109], v[110:113], 0
    ds_read_b128 v[102:105], v84 offset:192
    ds_read_b128 v[110:113], v85 offset:192
    ds_read_b128 v[106:109], v84 offset:4544
    s_waitcnt lgkmcnt(7)
    v_mfma_f32_16x16x32_f16 v[34:37], v[114:117], v[122:125], v[34:37]
    s_waitcnt lgkmcnt(6)
    v_mfma_f32_16x16x32_f16 v[38:41], v[118:121], v[122:125], v[38:41]
    ds_read_b128 v[114:117], v84 offset:14416
    s_mov_b32 m0, s97
    s_nop 0
    buffer_load_dwordx4 v56, s[12:15], s96 offen offset:0 lds
    ds_read_b128 v[122:125], v85 offset:14416
    ds_read_b128 v[118:121], v84 offset:18768
    s_waitcnt lgkmcnt(7)
    v_mfma_f32_16x16x32_f16 v[34:37], v[126:129], v[134:137], v[34:37]
    s_waitcnt lgkmcnt(6)
    v_mfma_f32_16x16x32_f16 v[38:41], v[130:133], v[134:137], v[38:41]
    ds_read_b128 v[126:129], v84 offset:14480
    ds_read_b128 v[134:137], v85 offset:14480
    ds_read_b128 v[130:133], v84 offset:18832
    buffer_load_dwordx4 v57, s[12:15], s96 offen offset:1024 lds
    s_waitcnt lgkmcnt(7)
    v_mfma_f32_16x16x32_f16 v[34:37], v[102:105], v[110:113], v[34:37]
    s_waitcnt lgkmcnt(6)
    v_mfma_f32_16x16x32_f16 v[38:41], v[106:109], v[110:113], v[38:41]
    ds_read_b128 v[102:105], v84 offset:14544
    ds_read_b128 v[110:113], v85 offset:14544
    ds_read_b128 v[106:109], v84 offset:18896
    s_waitcnt lgkmcnt(7)
    v_mfma_f32_16x16x32_f16 v[34:37], v[114:117], v[122:125], v[34:37]
    s_waitcnt lgkmcnt(6)
    v_mfma_f32_16x16x32_f16 v[38:41], v[118:121], v[122:125], v[38:41]
    buffer_load_dwordx4 v58, s[12:15], s96 offen offset:2048 lds
    s_add_u32 s96, s96, 44032
    s_add_u32 s97, s97, 3072
    ds_read_b128 v[114:117], v84 offset:14608
    ds_read_b128 v[122:125], v85 offset:14608
    ds_read_b128 v[118:121], v84 offset:18960
    s_waitcnt lgkmcnt(7)
    v_mfma_f32_16x16x32_f16 v[34:37], v[126:129], v[134:137], v[34:37]
    s_waitcnt lgkmcnt(6)
    v_mfma_f32_16x16x32_f16 v[38:41], v[130:133], v[134:137], v[38:41]
    s_waitcnt lgkmcnt(4)
    v_mfma_f32_16x16x32_f16 v[34:37], v[102:105], v[110:113], v[34:37]
    s_waitcnt lgkmcnt(3)
    v_mfma_f32_16x16x32_f16 v[38:41], v[106:109], v[110:113], v[38:41]
    s_waitcnt lgkmcnt(1)
    v_mfma_f32_16x16x32_f16 v[34:37], v[114:117], v[122:125], v[34:37]
    s_waitcnt lgkmcnt(0)
    v_mfma_f32_16x16x32_f16 v[38:41], v[118:121], v[122:125], v[38:41]
    s_nop 5
    ds_write_b32 v86, v34 offset:0
    ds_write_b32 v86, v35 offset:4
    ds_write_b32 v87, v36 offset:0
    ds_write_b32 v87, v37 offset:4
    s_mov_b32 exec_hi, 0
    ds_write_b32 v88, v38 offset:0
    ds_write_b32 v88, v39 offset:128
    ds_write_b32 v88, v40 offset:256
    ds_write_b32 v88, v41 offset:384
    s_mov_b32 exec_hi, -1
    s_mov_b32 exec_lo, 0xff
    s_mov_b32 exec_hi, 0
    buffer_load_dword v34, v53, s[20:23], 0 offen sc1
    s_mov_b64 exec, -1
    s_waitcnt lgkmcnt(0)
    s_barrier
    ds_read_b32 v68, v90 offset:0
    ds_read_b32 v69, v91 offset:0
    ds_read_b32 v70, v92 offset:0
    ds_read_b32 v71, v93 offset:0
    ds_read_b32 v72, v94 offset:0
    ds_read_b32 v73, v95 offset:0
    ds_read_b32 v74, v96 offset:0
    ds_read_b32 v75, v97 offset:0
    ds_read_b32 v76, v98 offset:0
    ds_read_b32 v77, v99 offset:0
    ds_read_b32 v78, v100 offset:0
    ds_read_b32 v79, v90 offset:3104
    ds_read_b32 v80, v91 offset:3104
    ds_read_b32 v81, v92 offset:3104
    ds_read_b32 v82, v93 offset:3104
    ds_read_b32 v83, v94 offset:3104
    ds_read_b32 v84, v95 offset:3104
    ds_read_b32 v85, v96 offset:3104
    ds_read_b32 v86, v97 offset:3104
    ds_read_b32 v87, v98 offset:3104
    ds_read_b32 v88, v99 offset:3104
    ds_read_b32 v89, v100 offset:3104
    v_lshlrev_b32 v35, 4, v0
    v_add_u32 v35, 98384, v35
    s_waitcnt lgkmcnt(14)
    v_cvt_pk_f16_f32 v102, v75, v74
    v_cvt_pk_f16_f32 v103, v73, v72
    v_cvt_pk_f16_f32 v104, v71, v70
    v_cvt_pk_f16_f32 v105, v69, v68
    ds_write_b128 v35, v[102:105] offset:0
    s_waitcnt lgkmcnt(14)
    v_cvt_pk_f16_f32 v106, v76, v75
    v_cvt_pk_f16_f32 v107, v74, v73
    v_cvt_pk_f16_f32 v108, v72, v71
    v_cvt_pk_f16_f32 v109, v70, v69
    ds_write_b128 v35, v[106:109] offset:4416
    s_waitcnt lgkmcnt(14)
    v_cvt_pk_f16_f32 v110, v77, v76
    v_cvt_pk_f16_f32 v111, v75, v74
    v_cvt_pk_f16_f32 v112, v73, v72
    v_cvt_pk_f16_f32 v113, v71, v70
    ds_write_b128 v35, v[110:113] offset:8832
    s_waitcnt lgkmcnt(14)
    v_cvt_pk_f16_f32 v114, v78, v77
    s_mov_b32 s38, 0
    s_mov_b32 exec_lo, 0xff
    s_mov_b32 exec_hi, 0
L_A1c_11:
    s_waitcnt vmcnt(0)
    v_cmp_ne_u32 vcc, s46, v34
    s_nop 0
    s_cmp_eq_u64 vcc, 0
    s_cbranch_scc1 L_A1d_12
    s_add_u32 s38, s38, 1
    s_cmp_lt_u32 s38, 0x40000
    s_cbranch_scc0 L_A1_10
    buffer_load_dword v34, v53, s[20:23], 0 offen sc1
    s_waitcnt vmcnt(0)
    s_branch L_A1c_11
L_A1_10:
    v_mov_b32 v36, 0
    v_mov_b32 v37, 0xdead
    global_store_dword v36, v37, s[92:93]
L_A1d_12:
    s_mov_b64 exec, -1
    s_lshl_b32 s40, s5, 2
    s_add_u32 s40, s40, s4
    s_lshl_b32 s40, s40, 15
    s_add_u32 s40, s40, 0
    buffer_load_dwordx4 a[0:3], v2, s[20:23], s40 offen offset:0 sc1
    v_cvt_pk_f16_f32 v115, v76, v75
    v_cvt_pk_f16_f32 v116, v74, v73
    v_cvt_pk_f16_f32 v117, v72, v71
    buffer_load_dwordx4 a[4:7], v2, s[20:23], s40 offen offset:1024 sc1
    ds_write_b128 v35, v[114:117] offset:13248
    s_waitcnt lgkmcnt(7)
    v_cvt_pk_f16_f32 v102, v86, v85
    buffer_load_dwordx4 a[8:11], v2, s[20:23], s40 offen offset:2048 sc1
    v_cvt_pk_f16_f32 v103, v84, v83
    v_cvt_pk_f16_f32 v104, v82, v81
    v_cvt_pk_f16_f32 v105, v80, v79
    buffer_load_dwordx4 a[12:15], v2, s[20:23], s40 offen offset:3072 sc1
    ds_write_b128 v35, v[102:105] offset:17664
    s_waitcnt lgkmcnt(7)
    v_cvt_pk_f16_f32 v106, v87, v86
    s_add_u32 s40, s40, 4096
    buffer_load_dwordx4 a[16:19], v2, s[20:23], s40 offen offset:0 sc1
    v_cvt_pk_f16_f32 v107, v85, v84
    v_cvt_pk_f16_f32 v108, v83, v82
    buffer_load_dwordx4 a[20:23], v2, s[20:23], s40 offen offset:1024 sc1
    v_cvt_pk_f16_f32 v109, v81, v80
    ds_write_b128 v35, v[106:109] offset:22080
    s_waitcnt lgkmcnt(7)
    v_cvt_pk_f16_f32 v110, v88, v87
    buffer_load_dwordx4 a[24:27], v2, s[20:23], s40 offen offset:2048 sc1
    v_cvt_pk_f16_f32 v111, v86, v85
    v_cvt_pk_f16_f32 v112, v84, v83
    buffer_load_dwordx4 a[28:31], v2, s[20:23], s40 offen offset:3072 sc1
    v_cvt_pk_f16_f32 v113, v82, v81
    ds_write_b128 v35, v[110:113] offset:26496
    s_waitcnt lgkmcnt(7)
    v_cvt_pk_f16_f32 v114, v89, v88
    s_add_u32 s40, s40, 4096
    buffer_load_dwordx4 a[32:35], v2, s[20:23], s40 offen offset:0 sc1
    v_cvt_pk_f16_f32 v115, v87, v86
    v_cvt_pk_f16_f32 v116, v85, v84
    buffer_load_dwordx4 a[36:39], v2, s[20:23], s40 offen offset:1024 sc1
    v_cvt_pk_f16_f32 v117, v83, v82
    ds_write_b128 v35, v[114:117] offset:30912
    s_cmp_eq_u32 s4, 0
    s_cbranch_scc0 L_x1_7
    v_bfe_u32 v68, v1, 3, 2
    v_and_b32 v69, 7, v1
    v_sub_u32 v70, v69, v68
    v_cmp_lt_i32 s[54:55], 4, v70
    v_mov_b32 v71, 158528
    v_mov_b32 v72, 158524
    v_cndmask_b32 v71, v71, v72, s[54:55]
    v_mul_u32_u24 v73, 3104, v4
    v_add_u32 v71, v71, v73
    ds_read_b32 v71, v71
    v_mul_u32_u24 v72, 17664, v4
    v_mul_u32_u24 v68, 4416, v68
    v_add_u32 v68, v68, v72
    v_lshlrev_b32 v69, 1, v69
    v_add_u32 v68, v68, v69
    v_add_u32 v68, 98368, v68
    s_waitcnt lgkmcnt(0)
    v_cvt_f16_f32 v71, v71
    ds_write_b16 v68, v71
    s_branch L_x3_9
L_x1_7:
    s_cmp_eq_u32 s4, 1
    s_cbranch_scc0 L_x2_8
    v_lshrrev_b32 v68, 3, v1
    v_mul_u32_u24 v68, 4416, v68
    v_and_b32 v69, 7, v1
    v_lshlrev_b32 v70, 4, v69
    v_lshrrev_b32 v69, 2, v69
    v_mul_u32_u24 v69, 4112, v69
    v_add_u32 v68, v68, v70
    v_add_u32 v68, v68, v69
    v_add_u32 v68, 98304, v68
    v_mov_b32 v72, 0
    v_mov_b32 v73, 0
    v_mov_b32 v74, 0
    v_mov_b32 v75, 0
    ds_write_b128 v68, v[72:75]
    s_branch L_x3_9
L_x2_8:
    s_sub_u32 s52, s4, 2
    s_mul_i32 s52, s52, 7680
    s_add_u32 s52, s52, 133632
    v_add_u32 v68, s52, v2
    v_mov_b32 v72, 0
    v_mov_b32 v73, 0
    v_mov_b32 v74, 0
    v_mov_b32 v75, 0
    ds_write_b128 v68, v[72:75]
    ds_write_b128 v68, v[72:75] offset:1024
    s_mov_b32 exec_hi, 0
    ds_write_b128 v68, v[72:75] offset:2048
    s_mov_b32 exec_hi, -1
L_x3_9:
    s_waitcnt lgkmcnt(0)
    s_barrier
    s_mov_b32 s34, 0x3fb8aa3b
    s_lshl_b32 s56, s5, 2
    s_add_u32 s56, s56, s4
    s_mul_i32 s35, s56, 88064
    s_lshl_b32 s59, s6, 11
    s_add_u32 s35, s35, s59
    s_add_u32 s35, s35, 4194304
    ds_read_b128 v[68:71], v66 offset:0
    ds_read_b128 v[72:75], v66 offset:32
    ds_read_b128 v[76:79], v66 offset:64
    ds_read_b128 v[80:83], v66 offset:96
    ds_read_b128 v[84:87], v66 offset:128
    ds_read_b128 v[88:91], v66 offset:160
    ds_read_b128 v[92:95], v66 offset:192
    ds_read_b128 v[96:99], v66 offset:224
    ds_read_b128 v[100:103], v66 offset:256
    ds_read_b128 v[104:107], v66 offset:288
    ds_read_b128 v[108:111], v66 offset:320
    ds_read_b128 v[112:115], v66 offset:352
    ds_read_b64_tr_b16 v[116:117], v64 offset:0
    ds_read_b64_tr_b16 v[118:119], v64 offset:768
    ds_read_b64_tr_b16 v[120:121], v64 offset:64
    ds_read_b64_tr_b16 v[122:123], v64 offset:832
    ds_read_b64_tr_b16 v[124:125], v64 offset:128
    ds_read_b64_tr_b16 v[126:127], v64 offset:896
    ds_read_b64_tr_b16 v[128:129], v64 offset:3072
    ds_read_b64_tr_b16 v[130:131], v64 offset:3840
    ds_read_b64_tr_b16 v[132:133], v64 offset:3136
    ds_read_b64_tr_b16 v[134:135], v64 offset:3904
    ds_read_b64_tr_b16 v[136:137], v64 offset:3200
    ds_read_b64_tr_b16 v[138:139], v64 offset:3968
    buffer_load_dwordx4 a[40:43], v2, s[20:23], s40 offen offset:2048 sc1
    s_waitcnt vmcnt(10) lgkmcnt(10)
    v_mfma_f32_32x32x16_bf16 v[68:83], v[116:119], a[0:3], v[68:83]
    ds_read_b64_tr_b16 v[140:141], v64 offset:6144
    ds_read_b64_tr_b16 v[142:143], v64 offset:6912
    s_waitcnt lgkmcnt(10)
    v_mfma_f32_32x32x16_bf16 v[84:99], v[120:123], a[0:3], v[84:99]
    ds_read_b64_tr_b16 v[144:145], v64 offset:6208
    ds_read_b64_tr_b16 v[146:147], v64 offset:6976
    s_waitcnt lgkmcnt(10)
    v_mfma_f32_32x32x16_bf16 v[100:115], v[124:127], a[0:3], v[100:115]
    ds_read_b64_tr_b16 v[148:149], v64 offset:6272
    ds_read_b64_tr_b16 v[150:151], v64 offset:7040
    buffer_load_dwordx4 a[44:47], v2, s[20:23], s40 offen offset:3072 sc1
    s_waitcnt vmcnt(10) lgkmcnt(10)
    v_mfma_f32_32x32x16_bf16 v[68:83], v[128:131], a[4:7], v[68:83]
    ds_read_b64_tr_b16 v[116:117], v64 offset:9216
    ds_read_b64_tr_b16 v[118:119], v64 offset:9984
    s_waitcnt lgkmcnt(10)
    v_mfma_f32_32x32x16_bf16 v[84:99], v[132:135], a[4:7], v[84:99]
    ds_read_b64_tr_b16 v[120:121], v64 offset:9280
    ds_read_b64_tr_b16 v[122:123], v64 offset:10048
    s_waitcnt lgkmcnt(10)
    v_mfma_f32_32x32x16_bf16 v[100:115], v[136:139], a[4:7], v[100:115]
    ds_read_b64_tr_b16 v[124:125], v64 offset:9344
    ds_read_b64_tr_b16 v[126:127], v64 offset:10112
    s_add_u32 s40, s40, 4096
    buffer_load_dwordx4 a[48:51], v2, s[20:23], s40 offen offset:0 sc1
    s_waitcnt vmcnt(10) lgkmcnt(10)
    v_mfma_f32_32x32x16_bf16 v[68:83], v[140:143], a[8:11], v[68:83]
    ds_read_b64_tr_b16 v[128:129], v64 offset:12288
    ds_read_b64_tr_b16 v[130:131], v64 offset:13056
    s_waitcnt lgkmcnt(10)
    v_mfma_f32_32x32x16_bf16 v[84:99], v[144:147], a[8:11], v[84:99]
    ds_read_b64_tr_b16 v[132:133], v64 offset:12352
    ds_read_b64_tr_b16 v[134:135], v64 offset:13120
    s_waitcnt lgkmcnt(10)
    v_mfma_f32_32x32x16_bf16 v[100:115], v[148:151], a[8:11], v[100:115]
    ds_read_b64_tr_b16 v[136:137], v64 offset:12416
    ds_read_b64_tr_b16 v[138:139], v64 offset:13184
    buffer_load_dwordx4 a[52:55], v2, s[20:23], s40 offen offset:1024 sc1
    s_waitcnt vmcnt(10) lgkmcnt(10)
    v_mfma_f32_32x32x16_bf16 v[68:83], v[116:119], a[12:15], v[68:83]
    ds_read_b64_tr_b16 v[140:141], v64 offset:15360
    ds_read_b64_tr_b16 v[142:143], v64 offset:16128
    s_waitcnt lgkmcnt(10)
    v_mfma_f32_32x32x16_bf16 v[84:99], v[120:123], a[12:15], v[84:99]
    ds_read_b64_tr_b16 v[144:145], v64 offset:15424
    ds_read_b64_tr_b16 v[146:147], v64 offset:16192
    s_waitcnt lgkmcnt(10)
    v_mfma_f32_32x32x16_bf16 v[100:115], v[124:127], a[12:15], v[100:115]
    ds_read_b64_tr_b16 v[148:149], v64 offset:15488
    ds_read_b64_tr_b16 v[150:151], v64 offset:16256
    buffer_load_dwordx4 a[56:59], v2, s[20:23], s40 offen offset:2048 sc1
    s_waitcnt vmcnt(10) lgkmcnt(10)
    v_mfma_f32_32x32x16_bf16 v[68:83], v[128:131], a[16:19], v[68:83]
    ds_read_b64_tr_b16 v[116:117], v64 offset:18432
    ds_read_b64_tr_b16 v[118:119], v64 offset:19200
    s_waitcnt lgkmcnt(10)
    v_mfma_f32_32x32x16_bf16 v[84:99], v[132:135], a[16:19], v[84:99]
    ds_read_b64_tr_b16 v[120:121], v64 offset:18496
    ds_read_b64_tr_b16 v[122:123], v64 offset:19264
    s_waitcnt lgkmcnt(10)
    v_mfma_f32_32x32x16_bf16 v[100:115], v[136:139], a[16:19], v[100:115]
    ds_read_b64_tr_b16 v[124:125], v64 offset:18560
    ds_read_b64_tr_b16 v[126:127], v64 offset:19328
    buffer_load_dwordx4 a[60:63], v2, s[20:23], s40 offen offset:3072 sc1
    s_waitcnt vmcnt(10) lgkmcnt(10)
    v_mfma_f32_32x32x16_bf16 v[68:83], v[140:143], a[20:23], v[68:83]
    ds_read_b64_tr_b16 v[128:129], v64 offset:21504
    ds_read_b64_tr_b16 v[130:131], v64 offset:22272
    s_waitcnt lgkmcnt(10)
    v_mfma_f32_32x32x16_bf16 v[84:99], v[144:147], a[20:23], v[84:99]
    ds_read_b64_tr_b16 v[132:133], v64 offset:21568
    ds_read_b64_tr_b16 v[134:135], v64 offset:22336
    s_waitcnt lgkmcnt(10)
    v_mfma_f32_32x32x16_bf16 v[100:115], v[148:151], a[20:23], v[100:115]
    ds_read_b64_tr_b16 v[136:137], v64 offset:21632
    ds_read_b64_tr_b16 v[138:139], v64 offset:22400
    s_add_u32 s40, s40, 4096
    buffer_load_dwordx4 a[64:67], v2, s[20:23], s40 offen offset:0 sc1
    s_waitcnt vmcnt(10) lgkmcnt(10)
    v_mfma_f32_32x32x16_bf16 v[68:83], v[116:119], a[24:27], v[68:83]
    ds_read_b64_tr_b16 v[140:141], v64 offset:24576
    ds_read_b64_tr_b16 v[142:143], v64 offset:25344
    s_waitcnt lgkmcnt(10)
    v_mfma_f32_32x32x16_bf16 v[84:99], v[120:123], a[24:27], v[84:99]
    ds_read_b64_tr_b16 v[144:145], v64 offset:24640
    ds_read_b64_tr_b16 v[146:147], v64 offset:25408
    s_waitcnt lgkmcnt(10)
    v_mfma_f32_32x32x16_bf16 v[100:115], v[124:127], a[24:27], v[100:115]
    ds_read_b64_tr_b16 v[148:149], v64 offset:24704
    ds_read_b64_tr_b16 v[150:151], v64 offset:25472
    buffer_load_dwordx4 a[68:71], v2, s[20:23], s40 offen offset:1024 sc1
    s_waitcnt vmcnt(10) lgkmcnt(10)
    v_mfma_f32_32x32x16_bf16 v[68:83], v[128:131], a[28:31], v[68:83]
    ds_read_b64_tr_b16 v[116:117], v64 offset:27648
    ds_read_b64_tr_b16 v[118:119], v64 offset:28416
    s_waitcnt lgkmcnt(10)
    v_mfma_f32_32x32x16_bf16 v[84:99], v[132:135], a[28:31], v[84:99]
    ds_read_b64_tr_b16 v[120:121], v64 offset:27712
    ds_read_b64_tr_b16 v[122:123], v64 offset:28480
    s_waitcnt lgkmcnt(10)
    v_mfma_f32_32x32x16_bf16 v[100:115], v[136:139], a[28:31], v[100:115]
    ds_read_b64_tr_b16 v[124:125], v64 offset:27776
    ds_read_b64_tr_b16 v[126:127], v64 offset:28544
    buffer_load_dwordx4 a[72:75], v2, s[20:23], s40 offen offset:2048 sc1
    s_waitcnt vmcnt(10) lgkmcnt(10)
    v_mfma_f32_32x32x16_bf16 v[68:83], v[140:143], a[32:35], v[68:83]
    ds_read_b64_tr_b16 v[128:129], v64 offset:30720
    ds_read_b64_tr_b16 v[130:131], v64 offset:31488
    s_waitcnt lgkmcnt(10)
    v_mfma_f32_32x32x16_bf16 v[84:99], v[144:147], a[32:35], v[84:99]
    ds_read_b64_tr_b16 v[132:133], v64 offset:30784
    ds_read_b64_tr_b16 v[134:135], v64 offset:31552
    s_waitcnt lgkmcnt(10)
    v_mfma_f32_32x32x16_bf16 v[100:115], v[148:151], a[32:35], v[100:115]
    ds_read_b64_tr_b16 v[136:137], v64 offset:30848
    ds_read_b64_tr_b16 v[138:139], v64 offset:31616
    buffer_load_dwordx4 a[76:79], v2, s[20:23], s40 offen offset:3072 sc1
    s_waitcnt vmcnt(10) lgkmcnt(10)
    v_mfma_f32_32x32x16_bf16 v[68:83], v[116:119], a[36:39], v[68:83]
    ds_read_b64_tr_b16 v[140:141], v64 offset:33792
    ds_read_b64_tr_b16 v[142:143], v64 offset:34560
    s_waitcnt lgkmcnt(10)
    v_mfma_f32_32x32x16_bf16 v[84:99], v[120:123], a[36:39], v[84:99]
    ds_read_b64_tr_b16 v[144:145], v64 offset:33856
    ds_read_b64_tr_b16 v[146:147], v64 offset:34624
    s_waitcnt lgkmcnt(10)
    v_mfma_f32_32x32x16_bf16 v[100:115], v[124:127], a[36:39], v[100:115]
    ds_read_b64_tr_b16 v[148:149], v64 offset:33920
    ds_read_b64_tr_b16 v[150:151], v64 offset:34688
    s_add_u32 s40, s40, 4096
    buffer_load_dwordx4 a[80:83], v2, s[20:23], s40 offen offset:0 sc1
    s_waitcnt vmcnt(10) lgkmcnt(10)
    v_mfma_f32_32x32x16_bf16 v[68:83], v[128:131], a[40:43], v[68:83]
    ds_read_b64_tr_b16 v[116:117], v64 offset:36864
    ds_read_b64_tr_b16 v[118:119], v64 offset:37632
    s_waitcnt lgkmcnt(10)
    v_mfma_f32_32x32x16_bf16 v[84:99], v[132:135], a[40:43], v[84:99]
    ds_read_b64_tr_b16 v[120:121], v64 offset:36928
    ds_read_b64_tr_b16 v[122:123], v64 offset:37696
    s_waitcnt lgkmcnt(10)
    v_mfma_f32_32x32x16_bf16 v[100:115], v[136:139], a[40:43], v[100:115]
    ds_read_b64_tr_b16 v[124:125], v64 offset:36992
    ds_read_b64_tr_b16 v[126:127], v64 offset:37760
    buffer_load_dwordx4 a[84:87], v2, s[20:23], s40 offen offset:1024 sc1
    s_waitcnt vmcnt(10) lgkmcnt(10)
    v_mfma_f32_32x32x16_bf16 v[68:83], v[140:143], a[44:47], v[68:83]
    ds_read_b64_tr_b16 v[128:129], v64 offset:39936
    ds_read_b64_tr_b16 v[130:131], v64 offset:40704
    s_waitcnt lgkmcnt(10)
    v_mfma_f32_32x32x16_bf16 v[84:99], v[144:147], a[44:47], v[84:99]
    ds_read_b64_tr_b16 v[132:133], v64 offset:40000
    ds_read_b64_tr_b16 v[134:135], v64 offset:40768
    s_waitcnt lgkmcnt(10)
    v_mfma_f32_32x32x16_bf16 v[100:115], v[148:151], a[44:47], v[100:115]
    ds_read_b64_tr_b16 v[136:137], v64 offset:40064
    ds_read_b64_tr_b16 v[138:139], v64 offset:40832
    buffer_load_dwordx4 a[88:91], v2, s[20:23], s40 offen offset:2048 sc1
    s_waitcnt vmcnt(10) lgkmcnt(10)
    v_mfma_f32_32x32x16_bf16 v[68:83], v[116:119], a[48:51], v[68:83]
    ds_read_b64_tr_b16 v[140:141], v64 offset:43008
    ds_read_b64_tr_b16 v[142:143], v64 offset:43776
    s_waitcnt lgkmcnt(10)
    v_mfma_f32_32x32x16_bf16 v[84:99], v[120:123], a[48:51], v[84:99]
    ds_read_b64_tr_b16 v[144:145], v64 offset:43072
    ds_read_b64_tr_b16 v[146:147], v64 offset:43840
    s_waitcnt lgkmcnt(10)
    v_mfma_f32_32x32x16_bf16 v[100:115], v[124:127], a[48:51], v[100:115]
    ds_read_b64_tr_b16 v[148:149], v64 offset:43136
    ds_read_b64_tr_b16 v[150:151], v64 offset:43904
    buffer_load_dwordx4 a[92:95], v2, s[20:23], s40 offen offset:3072 sc1
    s_waitcnt vmcnt(10) lgkmcnt(10)
    v_mfma_f32_32x32x16_bf16 v[68:83], v[128:131], a[52:55], v[68:83]
    ds_read_b64_tr_b16 v[116:117], v64 offset:46080
    ds_read_b64_tr_b16 v[118:119], v64 offset:46848
    s_waitcnt lgkmcnt(10)
    v_mfma_f32_32x32x16_bf16 v[84:99], v[132:135], a[52:55], v[84:99]
    ds_read_b64_tr_b16 v[120:121], v64 offset:46144
    ds_read_b64_tr_b16 v[122:123], v64 offset:46912
    s_waitcnt lgkmcnt(10)
    v_mfma_f32_32x32x16_bf16 v[100:115], v[136:139], a[52:55], v[100:115]
    ds_read_b64_tr_b16 v[124:125], v64 offset:46208
    ds_read_b64_tr_b16 v[126:127], v64 offset:46976
    s_add_u32 s40, s40, 4096
    buffer_load_dwordx4 a[96:99], v2, s[20:23], s40 offen offset:0 sc1
    s_waitcnt vmcnt(10) lgkmcnt(10)
    v_mfma_f32_32x32x16_bf16 v[68:83], v[140:143], a[56:59], v[68:83]
    ds_read_b64_tr_b16 v[128:129], v65 offset:0
    ds_read_b64_tr_b16 v[130:131], v65 offset:768
    s_waitcnt lgkmcnt(10)
    v_mfma_f32_32x32x16_bf16 v[84:99], v[144:147], a[56:59], v[84:99]
    ds_read_b64_tr_b16 v[132:133], v65 offset:64
    ds_read_b64_tr_b16 v[134:135], v65 offset:832
    s_waitcnt lgkmcnt(10)
    v_mfma_f32_32x32x16_bf16 v[100:115], v[148:151], a[56:59], v[100:115]
    ds_read_b64_tr_b16 v[136:137], v65 offset:128
    ds_read_b64_tr_b16 v[138:139], v65 offset:896
    buffer_load_dwordx4 a[100:103], v2, s[20:23], s40 offen offset:1024 sc1
    s_waitcnt vmcnt(10) lgkmcnt(10)
    v_mfma_f32_32x32x16_bf16 v[68:83], v[116:119], a[60:63], v[68:83]
    ds_read_b64_tr_b16 v[140:141], v65 offset:3072
    ds_read_b64_tr_b16 v[142:143], v65 offset:3840
    s_waitcnt lgkmcnt(10)
    v_mfma_f32_32x32x16_bf16 v[84:99], v[120:123], a[60:63], v[84:99]
    ds_read_b64_tr_b16 v[144:145], v65 offset:3136
    ds_read_b64_tr_b16 v[146:147], v65 offset:3904
    s_waitcnt lgkmcnt(10)
    v_mfma_f32_32x32x16_bf16 v[100:115], v[124:127], a[60:63], v[100:115]
    ds_read_b64_tr_b16 v[148:149], v65 offset:3200
    ds_read_b64_tr_b16 v[150:151], v65 offset:3968
    buffer_load_dwordx4 a[104:107], v2, s[20:23], s40 offen offset:2048 sc1
    s_waitcnt vmcnt(10) lgkmcnt(10)
    v_mfma_f32_32x32x16_bf16 v[68:83], v[128:131], a[64:67], v[68:83]
    ds_read_b64_tr_b16 v[116:117], v65 offset:6144
    ds_read_b64_tr_b16 v[118:119], v65 offset:6912
    s_waitcnt lgkmcnt(10)
    v_mfma_f32_32x32x16_bf16 v[84:99], v[132:135], a[64:67], v[84:99]
    ds_read_b64_tr_b16 v[120:121], v65 offset:6208
    ds_read_b64_tr_b16 v[122:123], v65 offset:6976
    s_waitcnt lgkmcnt(10)
    v_mfma_f32_32x32x16_bf16 v[100:115], v[136:139], a[64:67], v[100:115]
    ds_read_b64_tr_b16 v[124:125], v65 offset:6272
    ds_read_b64_tr_b16 v[126:127], v65 offset:7040
    buffer_load_dwordx4 a[108:111], v2, s[20:23], s40 offen offset:3072 sc1
    s_waitcnt vmcnt(10) lgkmcnt(10)
    v_mfma_f32_32x32x16_bf16 v[68:83], v[140:143], a[68:71], v[68:83]
    ds_read_b64_tr_b16 v[128:129], v65 offset:9216
    ds_read_b64_tr_b16 v[130:131], v65 offset:9984
    s_waitcnt lgkmcnt(10)
    v_mfma_f32_32x32x16_bf16 v[84:99], v[144:147], a[68:71], v[84:99]
    ds_read_b64_tr_b16 v[132:133], v65 offset:9280
    ds_read_b64_tr_b16 v[134:135], v65 offset:10048
    s_waitcnt lgkmcnt(10)
    v_mfma_f32_32x32x16_bf16 v[100:115], v[148:151], a[68:71], v[100:115]
    ds_read_b64_tr_b16 v[136:137], v65 offset:9344
    ds_read_b64_tr_b16 v[138:139], v65 offset:10112
    s_add_u32 s40, s40, 4096
    buffer_load_dwordx4 a[112:115], v2, s[20:23], s40 offen offset:0 sc1
    s_waitcnt vmcnt(10) lgkmcnt(10)
    v_mfma_f32_32x32x16_bf16 v[68:83], v[116:119], a[72:75], v[68:83]
    ds_read_b64_tr_b16 v[140:141], v65 offset:12288
    ds_read_b64_tr_b16 v[142:143], v65 offset:13056
    s_waitcnt lgkmcnt(10)
    v_mfma_f32_32x32x16_bf16 v[84:99], v[120:123], a[72:75], v[84:99]
    ds_read_b64_tr_b16 v[144:145], v65 offset:12352
    ds_read_b64_tr_b16 v[146:147], v65 offset:13120
    s_waitcnt lgkmcnt(10)
    v_mfma_f32_32x32x16_bf16 v[100:115], v[124:127], a[72:75], v[100:115]
    ds_read_b64_tr_b16 v[148:149], v65 offset:12416
    ds_read_b64_tr_b16 v[150:151], v65 offset:13184
    buffer_load_dwordx4 a[116:119], v2, s[20:23], s40 offen offset:1024 sc1
    s_waitcnt vmcnt(10) lgkmcnt(10)
    v_mfma_f32_32x32x16_bf16 v[68:83], v[128:131], a[76:79], v[68:83]
    ds_read_b64_tr_b16 v[116:117], v65 offset:15360
    ds_read_b64_tr_b16 v[118:119], v65 offset:16128
    s_waitcnt lgkmcnt(10)
    v_mfma_f32_32x32x16_bf16 v[84:99], v[132:135], a[76:79], v[84:99]
    ds_read_b64_tr_b16 v[120:121], v65 offset:15424
    ds_read_b64_tr_b16 v[122:123], v65 offset:16192
    s_waitcnt lgkmcnt(10)
    v_mfma_f32_32x32x16_bf16 v[100:115], v[136:139], a[76:79], v[100:115]
    ds_read_b64_tr_b16 v[124:125], v65 offset:15488
    ds_read_b64_tr_b16 v[126:127], v65 offset:16256
    buffer_load_dwordx4 a[120:123], v2, s[20:23], s40 offen offset:2048 sc1
    s_waitcnt vmcnt(10) lgkmcnt(10)
    v_mfma_f32_32x32x16_bf16 v[68:83], v[140:143], a[80:83], v[68:83]
    ds_read_b64_tr_b16 v[128:129], v65 offset:18432
    ds_read_b64_tr_b16 v[130:131], v65 offset:19200
    s_waitcnt lgkmcnt(10)
    v_mfma_f32_32x32x16_bf16 v[84:99], v[144:147], a[80:83], v[84:99]
    ds_read_b64_tr_b16 v[132:133], v65 offset:18496
    ds_read_b64_tr_b16 v[134:135], v65 offset:19264
    s_waitcnt lgkmcnt(10)
    v_mfma_f32_32x32x16_bf16 v[100:115], v[148:151], a[80:83], v[100:115]
    ds_read_b64_tr_b16 v[136:137], v65 offset:18560
    ds_read_b64_tr_b16 v[138:139], v65 offset:19328
    buffer_load_dwordx4 a[124:127], v2, s[20:23], s40 offen offset:3072 sc1
    s_waitcnt vmcnt(10) lgkmcnt(10)
    v_mfma_f32_32x32x16_bf16 v[68:83], v[116:119], a[84:87], v[68:83]
    ds_read_b64_tr_b16 v[140:141], v65 offset:21504
    ds_read_b64_tr_b16 v[142:143], v65 offset:22272
    s_waitcnt lgkmcnt(10)
    v_mfma_f32_32x32x16_bf16 v[84:99], v[120:123], a[84:87], v[84:99]
    ds_read_b64_tr_b16 v[144:145], v65 offset:21568
    ds_read_b64_tr_b16 v[146:147], v65 offset:22336
    s_waitcnt lgkmcnt(10)
    v_mfma_f32_32x32x16_bf16 v[100:115], v[124:127], a[84:87], v[100:115]
    ds_read_b64_tr_b16 v[148:149], v65 offset:21632
    ds_read_b64_tr_b16 v[150:151], v65 offset:22400
    s_waitcnt vmcnt(9) lgkmcnt(10)
    v_mfma_f32_32x32x16_bf16 v[68:83], v[128:131], a[88:91], v[68:83]
    ds_read_b64_tr_b16 v[116:117], v65 offset:24576
    ds_read_b64_tr_b16 v[118:119], v65 offset:25344
    s_waitcnt lgkmcnt(10)
    v_mfma_f32_32x32x16_bf16 v[84:99], v[132:135], a[88:91], v[84:99]
    ds_read_b64_tr_b16 v[120:121], v65 offset:24640
    ds_read_b64_tr_b16 v[122:123], v65 offset:25408
    s_waitcnt lgkmcnt(10)
    v_mfma_f32_32x32x16_bf16 v[100:115], v[136:139], a[88:91], v[100:115]
    ds_read_b64_tr_b16 v[124:125], v65 offset:24704
    ds_read_b64_tr_b16 v[126:127], v65 offset:25472
    buffer_load_dwordx4 v[46:49], v18, s[20:23], 0 offen sc1
    s_waitcnt vmcnt(9) lgkmcnt(10)
    v_mfma_f32_32x32x16_bf16 v[68:83], v[140:143], a[92:95], v[68:83]
    ds_read_b64_tr_b16 v[128:129], v65 offset:27648
    ds_read_b64_tr_b16 v[130:131], v65 offset:28416
    s_waitcnt lgkmcnt(10)
    v_mfma_f32_32x32x16_bf16 v[84:99], v[144:147], a[92:95], v[84:99]
    ds_read_b64_tr_b16 v[132:133], v65 offset:27712
    ds_read_b64_tr_b16 v[134:135], v65 offset:28480
    s_waitcnt lgkmcnt(10)
    v_mfma_f32_32x32x16_bf16 v[100:115], v[148:151], a[92:95], v[100:115]
    ds_read_b64_tr_b16 v[136:137], v65 offset:27776
    ds_read_b64_tr_b16 v[138:139], v65 offset:28544
    s_waitcnt vmcnt(8) lgkmcnt(10)
    v_mfma_f32_32x32x16_bf16 v[68:83], v[116:119], a[96:99], v[68:83]
    ds_read_b64_tr_b16 v[140:141], v65 offset:30720
    ds_read_b64_tr_b16 v[142:143], v65 offset:31488
    s_waitcnt lgkmcnt(10)
    v_mfma_f32_32x32x16_bf16 v[84:99], v[120:123], a[96:99], v[84:99]
    ds_read_b64_tr_b16 v[144:145], v65 offset:30784
    ds_read_b64_tr_b16 v[146:147], v65 offset:31552
    s_waitcnt lgkmcnt(10)
    v_mfma_f32_32x32x16_bf16 v[100:115], v[124:127], a[96:99], v[100:115]
    ds_read_b64_tr_b16 v[148:149], v65 offset:30848
    ds_read_b64_tr_b16 v[150:151], v65 offset:31616
    s_waitcnt vmcnt(7) lgkmcnt(10)
    v_mfma_f32_32x32x16_bf16 v[68:83], v[128:131], a[100:103], v[68:83]
    ds_read_b64_tr_b16 v[116:117], v65 offset:33792
    ds_read_b64_tr_b16 v[118:119], v65 offset:34560
    s_waitcnt lgkmcnt(10)
    v_mfma_f32_32x32x16_bf16 v[84:99], v[132:135], a[100:103], v[84:99]
    ds_read_b64_tr_b16 v[120:121], v65 offset:33856
    ds_read_b64_tr_b16 v[122:123], v65 offset:34624
    s_waitcnt lgkmcnt(10)
    v_mfma_f32_32x32x16_bf16 v[100:115], v[136:139], a[100:103], v[100:115]
    ds_read_b64_tr_b16 v[124:125], v65 offset:33920
    ds_read_b64_tr_b16 v[126:127], v65 offset:34688
    s_waitcnt vmcnt(6) lgkmcnt(10)
    v_mfma_f32_32x32x16_bf16 v[68:83], v[140:143], a[104:107], v[68:83]
    ds_read_b64_tr_b16 v[128:129], v65 offset:36864
    ds_read_b64_tr_b16 v[130:131], v65 offset:37632
    s_waitcnt lgkmcnt(10)
    v_mfma_f32_32x32x16_bf16 v[84:99], v[144:147], a[104:107], v[84:99]
    ds_read_b64_tr_b16 v[132:133], v65 offset:36928
    ds_read_b64_tr_b16 v[134:135], v65 offset:37696
    s_waitcnt lgkmcnt(10)
    v_mfma_f32_32x32x16_bf16 v[100:115], v[148:151], a[104:107], v[100:115]
    ds_read_b64_tr_b16 v[136:137], v65 offset:36992
    ds_read_b64_tr_b16 v[138:139], v65 offset:37760
    s_mov_b32 s38, 0
L_A2c_14:
    s_waitcnt vmcnt(0)
    v_cmp_ne_u32 vcc, s46, v46
    v_cmp_ne_u32 s[36:37], s46, v48
    s_nop 0
    s_or_b64 vcc, vcc, s[36:37]
    s_cmp_eq_u64 vcc, 0
    s_cbranch_scc1 L_A2d_15
    s_add_u32 s38, s38, 1
    s_cmp_lt_u32 s38, 0x40000
    s_cbranch_scc0 L_A2_13
    buffer_load_dwordx4 v[46:49], v18, s[20:23], 0 offen sc1
    s_waitcnt vmcnt(0)
    s_branch L_A2c_14
L_A2_13:
    v_mov_b32 v50, 0
    v_mov_b32 v51, 0xdead
    global_store_dword v50, v51, s[92:93]
L_A2d_15:
    s_lshl_b32 s56, s4, 19
    s_lshl_b32 s57, s3, 5
    s_add_u32 s56, s56, s57
    s_add_u32 s56, s56, 2097152
    buffer_load_dwordx4 v[34:37], v16, s[20:23], s56 offen sc1
    buffer_load_dwordx4 v[38:41], v16, s[20:23], s56 offen offset:16 sc1
    s_waitcnt lgkmcnt(10)
    v_mfma_f32_32x32x16_bf16 v[68:83], v[116:119], a[108:111], v[68:83]
    ds_read_b64_tr_b16 v[140:141], v65 offset:39936
    ds_read_b64_tr_b16 v[142:143], v65 offset:40704
    s_waitcnt lgkmcnt(10)
    v_mfma_f32_32x32x16_bf16 v[84:99], v[120:123], a[108:111], v[84:99]
    ds_read_b64_tr_b16 v[144:145], v65 offset:40000
    ds_read_b64_tr_b16 v[146:147], v65 offset:40768
    s_waitcnt lgkmcnt(10)
    v_mfma_f32_32x32x16_bf16 v[100:115], v[124:127], a[108:111], v[100:115]
    ds_read_b64_tr_b16 v[148:149], v65 offset:40064
    ds_read_b64_tr_b16 v[150:151], v65 offset:40832
    s_waitcnt lgkmcnt(10)
    v_mfma_f32_32x32x16_bf16 v[68:83], v[128:131], a[112:115], v[68:83]
    ds_read_b64_tr_b16 v[116:117], v65 offset:43008
    ds_read_b64_tr_b16 v[118:119], v65 offset:43776
    s_waitcnt lgkmcnt(10)
    v_mfma_f32_32x32x16_bf16 v[84:99], v[132:135], a[112:115], v[84:99]
    ds_read_b64_tr_b16 v[120:121], v65 offset:43072
    ds_read_b64_tr_b16 v[122:123], v65 offset:43840
    s_waitcnt lgkmcnt(10)
    v_mfma_f32_32x32x16_bf16 v[100:115], v[136:139], a[112:115], v[100:115]
    ds_read_b64_tr_b16 v[124:125], v65 offset:43136
    ds_read_b64_tr_b16 v[126:127], v65 offset:43904
    s_waitcnt lgkmcnt(10)
    v_mfma_f32_32x32x16_bf16 v[68:83], v[140:143], a[116:119], v[68:83]
    ds_read_b64_tr_b16 v[128:129], v65 offset:46080
    ds_read_b64_tr_b16 v[130:131], v65 offset:46848
    s_waitcnt lgkmcnt(10)
    v_mfma_f32_32x32x16_bf16 v[84:99], v[144:147], a[116:119], v[84:99]
    ds_read_b64_tr_b16 v[132:133], v65 offset:46144
    ds_read_b64_tr_b16 v[134:135], v65 offset:46912
    s_waitcnt lgkmcnt(10)
    v_mfma_f32_32x32x16_bf16 v[100:115], v[148:151], a[116:119], v[100:115]
    ds_read_b64_tr_b16 v[136:137], v65 offset:46208
    ds_read_b64_tr_b16 v[138:139], v65 offset:46976
    s_waitcnt lgkmcnt(10)
    v_mfma_f32_32x32x16_bf16 v[68:83], v[116:119], a[120:123], v[68:83]
    s_waitcnt lgkmcnt(8)
    v_mfma_f32_32x32x16_bf16 v[84:99], v[120:123], a[120:123], v[84:99]
    s_waitcnt lgkmcnt(6)
    v_mfma_f32_32x32x16_bf16 v[100:115], v[124:127], a[120:123], v[100:115]
    s_waitcnt lgkmcnt(4)
    v_mfma_f32_32x32x16_bf16 v[68:83], v[128:131], a[124:127], v[68:83]
    s_waitcnt lgkmcnt(2)
    v_mfma_f32_32x32x16_bf16 v[84:99], v[132:135], a[124:127], v[84:99]
    s_waitcnt lgkmcnt(0)
    v_mfma_f32_32x32x16_bf16 v[100:115], v[136:139], a[124:127], v[100:115]
    s_barrier
    s_mul_i32 s41, s32, 704512
    s_lshl_b32 s98, s33, 13
    s_add_u32 s41, s41, s98
    s_lshl_b32 s98, s48, 7
    s_add_u32 s41, s41, s98
    s_lshl_b32 s42, s32, 11
    s_lshl_b32 s98, s33, 10
    s_add_u32 s42, s42, s98
    s_lshl_b32 s51, s48, 14
    s_add_u32 m0, s42, 0
    s_add_u32 s97, s41, 0
    buffer_load_dwordx4 v19, s[16:19], s97 offen lds
    v_pk_mul_f32 v[152:153], v[68:69], s[34:35] op_sel_hi:[1,0]
    v_pk_mul_f32 v[154:155], v[70:71], s[34:35] op_sel_hi:[1,0]
    v_pk_mul_f32 v[156:157], v[72:73], s[34:35] op_sel_hi:[1,0]
    v_pk_mul_f32 v[158:159], v[74:75], s[34:35] op_sel_hi:[1,0]
    v_pk_mul_f32 v[160:161], v[76:77], s[34:35] op_sel_hi:[1,0]
    v_pk_mul_f32 v[162:163], v[78:79], s[34:35] op_sel_hi:[1,0]
    v_pk_mul_f32 v[164:165], v[80:81], s[34:35] op_sel_hi:[1,0]
    v_pk_mul_f32 v[166:167], v[82:83], s[34:35] op_sel_hi:[1,0]
    v_exp_f32 v152, v152
    v_exp_f32 v153, v153
    s_add_u32 m0, s42, 4096
    s_add_u32 s97, s41, 16384
    buffer_load_dwordx4 v19, s[16:19], s97 offen lds
    v_exp_f32 v154, v154
    v_exp_f32 v155, v155
    v_exp_f32 v156, v156
    v_exp_f32 v157, v157
    v_exp_f32 v158, v158
    v_exp_f32 v159, v159
    v_exp_f32 v160, v160
    v_exp_f32 v161, v161
    v_exp_f32 v162, v162
    v_exp_f32 v163, v163
    s_add_u32 m0, s42, 8192
    s_add_u32 s97, s41, 32768
    buffer_load_dwordx4 v19, s[16:19], s97 offen lds
    v_exp_f32 v164, v164
    v_exp_f32 v165, v165
    v_exp_f32 v166, v166
    v_exp_f32 v167, v167
    v_pk_add_f32 v[168:169], v[152:153], 2.0 op_sel_hi:[1,0]
    v_pk_fma_f32 v[152:153], v[152:153], v[168:169], 2.0 op_sel_hi:[1,1,0]
    v_pk_add_f32 v[170:171], v[154:155], 2.0 op_sel_hi:[1,0]
    v_pk_fma_f32 v[154:155], v[154:155], v[170:171], 2.0 op_sel_hi:[1,1,0]
    v_pk_add_f32 v[168:169], v[156:157], 2.0 op_sel_hi:[1,0]
    v_pk_fma_f32 v[156:157], v[156:157], v[168:169], 2.0 op_sel_hi:[1,1,0]
    s_add_u32 m0, s42, 12288
    s_add_u32 s97, s41, 49152
    buffer_load_dwordx4 v19, s[16:19], s97 offen lds
    v_pk_add_f32 v[170:171], v[158:159], 2.0 op_sel_hi:[1,0]
    v_pk_fma_f32 v[158:159], v[158:159], v[170:171], 2.0 op_sel_hi:[1,1,0]
    v_pk_add_f32 v[168:169], v[160:161], 2.0 op_sel_hi:[1,0]
    v_pk_fma_f32 v[160:161], v[160:161], v[168:169], 2.0 op_sel_hi:[1,1,0]
    v_pk_add_f32 v[170:171], v[162:163], 2.0 op_sel_hi:[1,0]
    v_pk_fma_f32 v[162:163], v[162:163], v[170:171], 2.0 op_sel_hi:[1,1,0]
    v_pk_add_f32 v[168:169], v[164:165], 2.0 op_sel_hi:[1,0]
    v_pk_fma_f32 v[164:165], v[164:165], v[168:169], 2.0 op_sel_hi:[1,1,0]
    v_pk_add_f32 v[170:171], v[166:167], 2.0 op_sel_hi:[1,0]
    v_pk_fma_f32 v[166:167], v[166:167], v[170:171], 2.0 op_sel_hi:[1,1,0]
    s_add_u32 m0, s42, 16384
    s_add_u32 s97, s41, 65536
    buffer_load_dwordx4 v19, s[16:19], s97 offen lds
    v_rcp_f32 v152, v152
    v_rcp_f32 v153, v153
    v_rcp_f32 v154, v154
    v_rcp_f32 v155, v155
    v_rcp_f32 v156, v156
    v_rcp_f32 v157, v157
    v_rcp_f32 v158, v158
    v_rcp_f32 v159, v159
    v_rcp_f32 v160, v160
    v_rcp_f32 v161, v161
    s_add_u32 m0, s42, 20480
    s_add_u32 s97, s41, 81920
    buffer_load_dwordx4 v19, s[16:19], s97 offen lds
    v_rcp_f32 v162, v162
    v_rcp_f32 v163, v163
    v_rcp_f32 v164, v164
    v_rcp_f32 v165, v165
    v_rcp_f32 v166, v166
    v_rcp_f32 v167, v167
    v_pk_fma_f32 v[152:153], v[152:153], -2.0, 1.0 op_sel_hi:[1,0,0]
    v_pk_fma_f32 v[154:155], v[154:155], -2.0, 1.0 op_sel_hi:[1,0,0]
    v_pk_fma_f32 v[156:157], v[156:157], -2.0, 1.0 op_sel_hi:[1,0,0]
    v_pk_fma_f32 v[158:159], v[158:159], -2.0, 1.0 op_sel_hi:[1,0,0]
    s_add_u32 m0, s42, 24576
    s_add_u32 s97, s41, 98304
    buffer_load_dwordx4 v19, s[16:19], s97 offen lds
    v_pk_fma_f32 v[160:161], v[160:161], -2.0, 1.0 op_sel_hi:[1,0,0]
    v_pk_fma_f32 v[162:163], v[162:163], -2.0, 1.0 op_sel_hi:[1,0,0]
    v_pk_fma_f32 v[164:165], v[164:165], -2.0, 1.0 op_sel_hi:[1,0,0]
    v_pk_fma_f32 v[166:167], v[166:167], -2.0, 1.0 op_sel_hi:[1,0,0]
    v_pk_mul_f32 v[152:153], v[152:153], v[68:69]
    v_pk_mul_f32 v[154:155], v[154:155], v[70:71]
    v_pk_mul_f32 v[156:157], v[156:157], v[72:73]
    v_pk_mul_f32 v[158:159], v[158:159], v[74:75]
    v_pk_mul_f32 v[160:161], v[160:161], v[76:77]
    v_pk_mul_f32 v[162:163], v[162:163], v[78:79]
    s_add_u32 m0, s42, 28672
    s_add_u32 s97, s41, 114688
    buffer_load_dwordx4 v19, s[16:19], s97 offen lds
    v_pk_mul_f32 v[164:165], v[164:165], v[80:81]
    v_pk_mul_f32 v[166:167], v[166:167], v[82:83]
    v_cvt_pk_bf16_f32 v168, v152, v153
    v_cvt_pk_bf16_f32 v169, v154, v155
    v_cvt_pk_bf16_f32 v170, v156, v157
    v_cvt_pk_bf16_f32 v171, v158, v159
    v_cvt_pk_bf16_f32 v172, v160, v161
    v_cvt_pk_bf16_f32 v173, v162, v163
    v_cvt_pk_bf16_f32 v174, v164, v165
    v_cvt_pk_bf16_f32 v175, v166, v167
    s_add_u32 s39, s35, 0
    buffer_store_dwordx4 v[168:171], v2, s[20:23], s39 offen sc1
    buffer_store_dwordx4 v[172:175], v2, s[20:23], s39 offen offset:1024 sc1
    s_waitcnt vmcnt(11)
    ds_write_b128 v17, v[34:37]
    s_waitcnt vmcnt(10)
    ds_write_b128 v17, v[38:41] offset:7680
    s_add_u32 m0, s42, 32768
    s_add_u32 s97, s41, 131072
    buffer_load_dwordx4 v19, s[16:19], s97 offen lds
    v_pk_mul_f32 v[152:153], v[84:85], s[34:35] op_sel_hi:[1,0]
    v_pk_mul_f32 v[154:155], v[86:87], s[34:35] op_sel_hi:[1,0]
    v_pk_mul_f32 v[156:157], v[88:89], s[34:35] op_sel_hi:[1,0]
    v_pk_mul_f32 v[158:159], v[90:91], s[34:35] op_sel_hi:[1,0]
    v_pk_mul_f32 v[160:161], v[92:93], s[34:35] op_sel_hi:[1,0]
    v_pk_mul_f32 v[162:163], v[94:95], s[34:35] op_sel_hi:[1,0]
    v_pk_mul_f32 v[164:165], v[96:97], s[34:35] op_sel_hi:[1,0]
    v_pk_mul_f32 v[166:167], v[98:99], s[34:35] op_sel_hi:[1,0]
    v_exp_f32 v152, v152
    v_exp_f32 v153, v153
    s_add_u32 m0, s42, 36864
    s_add_u32 s97, s41, 147456
    buffer_load_dwordx4 v19, s[16:19], s97 offen lds
    v_exp_f32 v154, v154
    v_exp_f32 v155, v155
    v_exp_f32 v156, v156
    v_exp_f32 v157, v157
    v_exp_f32 v158, v158
    v_exp_f32 v159, v159
    v_exp_f32 v160, v160
    v_exp_f32 v161, v161
    v_exp_f32 v162, v162
    v_exp_f32 v163, v163
    s_add_u32 m0, s42, 40960
    s_add_u32 s97, s41, 163840
    buffer_load_dwordx4 v19, s[16:19], s97 offen lds
    v_exp_f32 v164, v164
    v_exp_f32 v165, v165
    v_exp_f32 v166, v166
    v_exp_f32 v167, v167
    v_pk_add_f32 v[176:177], v[152:153], 2.0 op_sel_hi:[1,0]
    v_pk_fma_f32 v[152:153], v[152:153], v[176:177], 2.0 op_sel_hi:[1,1,0]
    v_pk_add_f32 v[178:179], v[154:155], 2.0 op_sel_hi:[1,0]
    v_pk_fma_f32 v[154:155], v[154:155], v[178:179], 2.0 op_sel_hi:[1,1,0]
    v_pk_add_f32 v[176:177], v[156:157], 2.0 op_sel_hi:[1,0]
    v_pk_fma_f32 v[156:157], v[156:157], v[176:177], 2.0 op_sel_hi:[1,1,0]
    s_add_u32 m0, s42, 45056
    s_add_u32 s97, s41, 180224
    buffer_load_dwordx4 v19, s[16:19], s97 offen lds
    v_pk_add_f32 v[178:179], v[158:159], 2.0 op_sel_hi:[1,0]
    v_pk_fma_f32 v[158:159], v[158:159], v[178:179], 2.0 op_sel_hi:[1,1,0]
    v_pk_add_f32 v[176:177], v[160:161], 2.0 op_sel_hi:[1,0]
    v_pk_fma_f32 v[160:161], v[160:161], v[176:177], 2.0 op_sel_hi:[1,1,0]
    v_pk_add_f32 v[178:179], v[162:163], 2.0 op_sel_hi:[1,0]
    v_pk_fma_f32 v[162:163], v[162:163], v[178:179], 2.0 op_sel_hi:[1,1,0]
    v_pk_add_f32 v[176:177], v[164:165], 2.0 op_sel_hi:[1,0]
    v_pk_fma_f32 v[164:165], v[164:165], v[176:177], 2.0 op_sel_hi:[1,1,0]
    v_pk_add_f32 v[178:179], v[166:167], 2.0 op_sel_hi:[1,0]
    v_pk_fma_f32 v[166:167], v[166:167], v[178:179], 2.0 op_sel_hi:[1,1,0]
    s_add_u32 m0, s42, 49152
    s_add_u32 s97, s41, 196608
    buffer_load_dwordx4 v19, s[16:19], s97 offen lds
    v_rcp_f32 v152, v152
    v_rcp_f32 v153, v153
    v_rcp_f32 v154, v154
    v_rcp_f32 v155, v155
    v_rcp_f32 v156, v156
    v_rcp_f32 v157, v157
    v_rcp_f32 v158, v158
    v_rcp_f32 v159, v159
    v_rcp_f32 v160, v160
    v_rcp_f32 v161, v161
    s_add_u32 m0, s42, 53248
    s_add_u32 s97, s41, 212992
    buffer_load_dwordx4 v19, s[16:19], s97 offen lds
    v_rcp_f32 v162, v162
    v_rcp_f32 v163, v163
    v_rcp_f32 v164, v164
    v_rcp_f32 v165, v165
    v_rcp_f32 v166, v166
    v_rcp_f32 v167, v167
    v_pk_fma_f32 v[152:153], v[152:153], -2.0, 1.0 op_sel_hi:[1,0,0]
    v_pk_fma_f32 v[154:155], v[154:155], -2.0, 1.0 op_sel_hi:[1,0,0]
    v_pk_fma_f32 v[156:157], v[156:157], -2.0, 1.0 op_sel_hi:[1,0,0]
    v_pk_fma_f32 v[158:159], v[158:159], -2.0, 1.0 op_sel_hi:[1,0,0]
    s_add_u32 m0, s42, 57344
    s_add_u32 s97, s41, 229376
    buffer_load_dwordx4 v19, s[16:19], s97 offen lds
    v_pk_fma_f32 v[160:161], v[160:161], -2.0, 1.0 op_sel_hi:[1,0,0]
    v_pk_fma_f32 v[162:163], v[162:163], -2.0, 1.0 op_sel_hi:[1,0,0]
    v_pk_fma_f32 v[164:165], v[164:165], -2.0, 1.0 op_sel_hi:[1,0,0]
    v_pk_fma_f32 v[166:167], v[166:167], -2.0, 1.0 op_sel_hi:[1,0,0]
    v_pk_mul_f32 v[152:153], v[152:153], v[84:85]
    v_pk_mul_f32 v[154:155], v[154:155], v[86:87]
    v_pk_mul_f32 v[156:157], v[156:157], v[88:89]
    v_pk_mul_f32 v[158:159], v[158:159], v[90:91]
    v_pk_mul_f32 v[160:161], v[160:161], v[92:93]
    v_pk_mul_f32 v[162:163], v[162:163], v[94:95]
    s_add_u32 m0, s42, 61440
    s_add_u32 s97, s41, 245760
    buffer_load_dwordx4 v19, s[16:19], s97 offen lds
    v_pk_mul_f32 v[164:165], v[164:165], v[96:97]
    v_pk_mul_f32 v[166:167], v[166:167], v[98:99]
    v_cvt_pk_bf16_f32 v176, v152, v153
    v_cvt_pk_bf16_f32 v177, v154, v155
    v_cvt_pk_bf16_f32 v178, v156, v157
    v_cvt_pk_bf16_f32 v179, v158, v159
    v_cvt_pk_bf16_f32 v180, v160, v161
    v_cvt_pk_bf16_f32 v181, v162, v163
    v_cvt_pk_bf16_f32 v182, v164, v165
    v_cvt_pk_bf16_f32 v183, v166, v167
    s_add_u32 s39, s35, 2048
    buffer_store_dwordx4 v[176:179], v2, s[20:23], s39 offen sc1
    buffer_store_dwordx4 v[180:183], v2, s[20:23], s39 offen offset:1024 sc1
    s_add_u32 m0, s42, 65536
    s_add_u32 s97, s41, 262144
    buffer_load_dwordx4 v19, s[16:19], s97 offen lds
    v_pk_mul_f32 v[152:153], v[100:101], s[34:35] op_sel_hi:[1,0]
    v_pk_mul_f32 v[154:155], v[102:103], s[34:35] op_sel_hi:[1,0]
    v_pk_mul_f32 v[156:157], v[104:105], s[34:35] op_sel_hi:[1,0]
    v_pk_mul_f32 v[158:159], v[106:107], s[34:35] op_sel_hi:[1,0]
    v_pk_mul_f32 v[160:161], v[108:109], s[34:35] op_sel_hi:[1,0]
    v_pk_mul_f32 v[162:163], v[110:111], s[34:35] op_sel_hi:[1,0]
    v_pk_mul_f32 v[164:165], v[112:113], s[34:35] op_sel_hi:[1,0]
    v_pk_mul_f32 v[166:167], v[114:115], s[34:35] op_sel_hi:[1,0]
    v_exp_f32 v152, v152
    v_exp_f32 v153, v153
    s_add_u32 m0, s42, 69632
    s_add_u32 s97, s41, 278528
    buffer_load_dwordx4 v19, s[16:19], s97 offen lds
    v_exp_f32 v154, v154
    v_exp_f32 v155, v155
    v_exp_f32 v156, v156
    v_exp_f32 v157, v157
    v_exp_f32 v158, v158
    v_exp_f32 v159, v159
    v_exp_f32 v160, v160
    v_exp_f32 v161, v161
    v_exp_f32 v162, v162
    v_exp_f32 v163, v163
    s_add_u32 m0, s42, 73728
    s_add_u32 s97, s41, 294912
    buffer_load_dwordx4 v19, s[16:19], s97 offen lds
    v_exp_f32 v164, v164
    v_exp_f32 v165, v165
    v_exp_f32 v166, v166
    v_exp_f32 v167, v167
    v_pk_add_f32 v[168:169], v[152:153], 2.0 op_sel_hi:[1,0]
    v_pk_fma_f32 v[152:153], v[152:153], v[168:169], 2.0 op_sel_hi:[1,1,0]
    v_pk_add_f32 v[170:171], v[154:155], 2.0 op_sel_hi:[1,0]
    v_pk_fma_f32 v[154:155], v[154:155], v[170:171], 2.0 op_sel_hi:[1,1,0]
    v_pk_add_f32 v[168:169], v[156:157], 2.0 op_sel_hi:[1,0]
    v_pk_fma_f32 v[156:157], v[156:157], v[168:169], 2.0 op_sel_hi:[1,1,0]
    s_add_u32 m0, s42, 77824
    s_add_u32 s97, s41, 311296
    buffer_load_dwordx4 v19, s[16:19], s97 offen lds
    v_pk_add_f32 v[170:171], v[158:159], 2.0 op_sel_hi:[1,0]
    v_pk_fma_f32 v[158:159], v[158:159], v[170:171], 2.0 op_sel_hi:[1,1,0]
    v_pk_add_f32 v[168:169], v[160:161], 2.0 op_sel_hi:[1,0]
    v_pk_fma_f32 v[160:161], v[160:161], v[168:169], 2.0 op_sel_hi:[1,1,0]
    v_pk_add_f32 v[170:171], v[162:163], 2.0 op_sel_hi:[1,0]
    v_pk_fma_f32 v[162:163], v[162:163], v[170:171], 2.0 op_sel_hi:[1,1,0]
    v_pk_add_f32 v[168:169], v[164:165], 2.0 op_sel_hi:[1,0]
    v_pk_fma_f32 v[164:165], v[164:165], v[168:169], 2.0 op_sel_hi:[1,1,0]
    v_pk_add_f32 v[170:171], v[166:167], 2.0 op_sel_hi:[1,0]
    v_pk_fma_f32 v[166:167], v[166:167], v[170:171], 2.0 op_sel_hi:[1,1,0]
    s_add_u32 m0, s42, 81920
    s_add_u32 s97, s41, 327680
    buffer_load_dwordx4 v19, s[16:19], s97 offen lds
    v_rcp_f32 v152, v152
    v_rcp_f32 v153, v153
    v_rcp_f32 v154, v154
    v_rcp_f32 v155, v155
    v_rcp_f32 v156, v156
    v_rcp_f32 v157, v157
    v_rcp_f32 v158, v158
    v_rcp_f32 v159, v159
    v_rcp_f32 v160, v160
    v_rcp_f32 v161, v161
    s_add_u32 m0, s42, 86016
    s_add_u32 s97, s41, 344064
    buffer_load_dwordx4 v19, s[16:19], s97 offen lds
    v_rcp_f32 v162, v162
    v_rcp_f32 v163, v163
    v_rcp_f32 v164, v164
    v_rcp_f32 v165, v165
    v_rcp_f32 v166, v166
    v_rcp_f32 v167, v167
    v_pk_fma_f32 v[152:153], v[152:153], -2.0, 1.0 op_sel_hi:[1,0,0]
    v_pk_fma_f32 v[154:155], v[154:155], -2.0, 1.0 op_sel_hi:[1,0,0]
    v_pk_fma_f32 v[156:157], v[156:157], -2.0, 1.0 op_sel_hi:[1,0,0]
    v_pk_fma_f32 v[158:159], v[158:159], -2.0, 1.0 op_sel_hi:[1,0,0]
    s_add_u32 m0, s42, 90112
    s_add_u32 s97, s41, 360448
    buffer_load_dwordx4 v19, s[16:19], s97 offen lds
    v_pk_fma_f32 v[160:161], v[160:161], -2.0, 1.0 op_sel_hi:[1,0,0]
    v_pk_fma_f32 v[162:163], v[162:163], -2.0, 1.0 op_sel_hi:[1,0,0]
    v_pk_fma_f32 v[164:165], v[164:165], -2.0, 1.0 op_sel_hi:[1,0,0]
    v_pk_fma_f32 v[166:167], v[166:167], -2.0, 1.0 op_sel_hi:[1,0,0]
    v_pk_mul_f32 v[152:153], v[152:153], v[100:101]
    v_pk_mul_f32 v[154:155], v[154:155], v[102:103]
    v_pk_mul_f32 v[156:157], v[156:157], v[104:105]
    v_pk_mul_f32 v[158:159], v[158:159], v[106:107]
    v_pk_mul_f32 v[160:161], v[160:161], v[108:109]
    v_pk_mul_f32 v[162:163], v[162:163], v[110:111]
    s_add_u32 m0, s42, 94208
    s_add_u32 s97, s41, 376832
    buffer_load_dwordx4 v19, s[16:19], s97 offen lds
    v_pk_mul_f32 v[164:165], v[164:165], v[112:113]
    v_pk_mul_f32 v[166:167], v[166:167], v[114:115]
    v_cvt_pk_bf16_f32 v168, v152, v153
    v_cvt_pk_bf16_f32 v169, v154, v155
    v_cvt_pk_bf16_f32 v170, v156, v157
    v_cvt_pk_bf16_f32 v171, v158, v159
    v_cvt_pk_bf16_f32 v172, v160, v161
    v_cvt_pk_bf16_f32 v173, v162, v163
    v_cvt_pk_bf16_f32 v174, v164, v165
    v_cvt_pk_bf16_f32 v175, v166, v167
    s_cmp_eq_u32 s7, 2
    s_cbranch_scc1 L_ast_16
    s_add_u32 s39, s35, 4096
    buffer_store_dwordx4 v[168:171], v2, s[20:23], s39 offen sc1
    buffer_store_dwordx4 v[172:175], v2, s[20:23], s39 offen offset:1024 sc1
L_ast_16:
    s_waitcnt vmcnt(10)
    s_waitcnt lgkmcnt(0)
    s_barrier
    s_or_b32 s52, s3, s4
    s_cmp_lg_u32 s52, 0
    s_cbranch_scc1 L_nw_17
    s_mov_b32 s101, 0
    s_add_u32 s100, s101, 12582912
    v_mov_b32 v16, s100
    v_mov_b32 v17, s46
    s_mov_b64 exec, 1
    buffer_store_dword v17, v16, s[20:23], 0 offen sc1
    s_mov_b64 exec, -1
L_nw_17:
    ds_read_b64 v[214:215], v7
    ds_read_b64 v[216:217], v7 offset:8
    ds_read_b128 v[222:225], v9
    ds_read_b128 v[226:229], v9 offset:2560
    ds_read_b64 v[182:183], v5 offset:992
    ds_read_b64 v[184:185], v5 offset:1000
    ds_read_b128 v[190:193], v8 offset:1232
    ds_read_b128 v[194:197], v8 offset:3792
    ds_read_b64 v[186:187], v6 offset:992
    ds_read_b64 v[188:189], v6 offset:1000
    ds_read_b64 v[198:199], v5 offset:960
    ds_read_b64 v[200:201], v5 offset:968
    ds_read_b128 v[206:209], v8 offset:1200
    ds_read_b128 v[210:213], v8 offset:3760
    ds_read_b64 v[202:203], v6 offset:960
    ds_read_b64 v[204:205], v6 offset:968
    s_waitcnt lgkmcnt(13)
    v_mfma_f32_32x32x16_f16 v[150:165], v[214:217], v[222:225], 0
    s_waitcnt lgkmcnt(12)
    v_mfma_f32_32x32x16_f16 v[166:181], v[214:217], v[226:229], 0
    s_lshl_b32 s56, s47, 16
    s_lshl_b32 s57, s33, 15
    s_add_u32 s56, s56, s57
    s_lshl_b32 s57, s48, 7
    s_add_u32 s56, s56, s57
    s_lshl_b32 s57, s32, 6
    s_add_u32 s39, s56, s57
    s_waitcnt lgkmcnt(9)
    v_mfma_f32_32x32x16_f16 v[150:165], v[182:185], v[190:193], v[150:165]
    ds_read_b64 v[214:215], v5 offset:928
    ds_read_b64 v[216:217], v5 offset:936
    ds_read_b128 v[222:225], v8 offset:1152
    s_waitcnt lgkmcnt(11)
    v_mfma_f32_32x32x16_f16 v[166:181], v[182:185], v[194:197], v[166:181]
    ds_read_b128 v[226:229], v8 offset:3712
    ds_read_b64 v[218:219], v6 offset:928
    ds_read_b64 v[220:221], v6 offset:936
    s_waitcnt lgkmcnt(12)
    v_mfma_f32_32x32x16_f16 v[166:181], v[186:189], v[190:193], v[166:181]
    s_add_u32 m0, s42, 148992
    s_add_u32 s97, s41, 655360
    buffer_load_dwordx4 v19, s[16:19], s97 offen lds
    ds_read_b64_tr_b16 a[0:1], v20 offset:0
    ds_read_b64_tr_b16 a[2:3], v20 offset:1024
    ds_read_b64_tr_b16 a[4:5], v21 offset:0
    ds_read_b64_tr_b16 a[6:7], v21 offset:1024
    s_waitcnt lgkmcnt(13)
    v_mfma_f32_32x32x16_f16 v[150:165], v[198:201], v[206:209], v[150:165]
    ds_read_b64 v[182:183], v5 offset:896
    ds_read_b64 v[184:185], v5 offset:904
    ds_read_b128 v[190:193], v8 offset:1120
    s_waitcnt lgkmcnt(14)
    v_mfma_f32_32x32x16_f16 v[166:181], v[198:201], v[210:213], v[166:181]
    ds_read_b128 v[194:197], v8 offset:3680
    ds_read_b64 v[186:187], v6 offset:896
    ds_read_b64 v[188:189], v6 offset:904
    s_waitcnt lgkmcnt(14)
    v_mfma_f32_32x32x16_f16 v[166:181], v[202:205], v[206:209], v[166:181]
    s_add_u32 m0, s42, 153088
    s_add_u32 s97, s41, 671744
    buffer_load_dwordx4 v19, s[16:19], s97 offen lds
    ds_read_b64_tr_b16 a[8:9], v20 offset:4096
    ds_read_b64_tr_b16 a[10:11], v20 offset:5120
    ds_read_b64_tr_b16 a[12:13], v21 offset:4096
    ds_read_b64_tr_b16 a[14:15], v21 offset:5120
    s_waitcnt lgkmcnt(14)
    v_mfma_f32_32x32x16_f16 v[150:165], v[214:217], v[222:225], v[150:165]
    ds_read_b64 v[198:199], v5 offset:864
    ds_read_b64 v[200:201], v5 offset:872
    ds_read_b128 v[206:209], v8 offset:1072
    v_mfma_f32_32x32x16_f16 v[166:181], v[214:217], v[226:229], v[166:181]
    ds_read_b128 v[210:213], v8 offset:3632
    ds_read_b64 v[202:203], v6 offset:864
    ds_read_b64 v[204:205], v6 offset:872
    v_mfma_f32_32x32x16_f16 v[166:181], v[218:221], v[222:225], v[166:181]
    s_add_u32 m0, s42, 157184
    s_add_u32 s97, s41, 688128
    buffer_load_dwordx4 v19, s[16:19], s97 offen lds
    ds_read_b64_tr_b16 a[16:17], v20 offset:8192
    ds_read_b64_tr_b16 a[18:19], v20 offset:9216
    ds_read_b64_tr_b16 a[20:21], v21 offset:8192
    ds_read_b64_tr_b16 a[22:23], v21 offset:9216
    s_waitcnt lgkmcnt(14)
    v_mfma_f32_32x32x16_f16 v[150:165], v[182:185], v[190:193], v[150:165]
    ds_read_b64 v[214:215], v5 offset:832
    ds_read_b64 v[216:217], v5 offset:840
    ds_read_b128 v[222:225], v8 offset:1040
    v_mfma_f32_32x32x16_f16 v[166:181], v[182:185], v[194:197], v[166:181]
    ds_read_b128 v[226:229], v8 offset:3600
    ds_read_b64 v[218:219], v6 offset:832
    ds_read_b64 v[220:221], v6 offset:840
    v_mfma_f32_32x32x16_f16 v[166:181], v[186:189], v[190:193], v[166:181]
    ds_read_b64_tr_b16 a[24:25], v20 offset:12288
    ds_read_b64_tr_b16 a[26:27], v20 offset:13312
    ds_read_b64_tr_b16 a[28:29], v21 offset:12288
    ds_read_b64_tr_b16 a[30:31], v21 offset:13312
    s_waitcnt lgkmcnt(14)
    v_mfma_f32_32x32x16_f16 v[150:165], v[198:201], v[206:209], v[150:165]
    ds_read_b64 v[182:183], v5 offset:800
    ds_read_b64 v[184:185], v5 offset:808
    ds_read_b128 v[190:193], v8 offset:992
    v_mfma_f32_32x32x16_f16 v[166:181], v[198:201], v[210:213], v[166:181]
    ds_read_b128 v[194:197], v8 offset:3552
    ds_read_b64 v[186:187], v6 offset:800
    ds_read_b64 v[188:189], v6 offset:808
    v_mfma_f32_32x32x16_f16 v[166:181], v[202:205], v[206:209], v[166:181]
    ds_read_b64_tr_b16 a[32:33], v20 offset:16384
    ds_read_b64_tr_b16 a[34:35], v20 offset:17408
    ds_read_b64_tr_b16 a[36:37], v21 offset:16384
    ds_read_b64_tr_b16 a[38:39], v21 offset:17408
    buffer_load_dwordx2 v[34:35], v33, s[8:11], s39 offen offset:0
    s_waitcnt lgkmcnt(14)
    v_mfma_f32_32x32x16_f16 v[150:165], v[214:217], v[222:225], v[150:165]
    ds_read_b64 v[198:199], v5 offset:768
    ds_read_b64 v[200:201], v5 offset:776
    ds_read_b128 v[206:209], v8 offset:960
    v_mfma_f32_32x32x16_f16 v[166:181], v[214:217], v[226:229], v[166:181]
    ds_read_b128 v[210:213], v8 offset:3520
    ds_read_b64 v[202:203], v6 offset:768
    ds_read_b64 v[204:205], v6 offset:776
    v_mfma_f32_32x32x16_f16 v[166:181], v[218:221], v[222:225], v[166:181]
    ds_read_b64_tr_b16 a[40:41], v20 offset:20480
    ds_read_b64_tr_b16 a[42:43], v20 offset:21504
    ds_read_b64_tr_b16 a[44:45], v21 offset:20480
    ds_read_b64_tr_b16 a[46:47], v21 offset:21504
    s_waitcnt lgkmcnt(14)
    v_mfma_f32_32x32x16_f16 v[150:165], v[182:185], v[190:193], v[150:165]
    ds_read_b64 v[214:215], v5 offset:736
    ds_read_b64 v[216:217], v5 offset:744
    ds_read_b128 v[222:225], v8 offset:912
    v_mfma_f32_32x32x16_f16 v[166:181], v[182:185], v[194:197], v[166:181]
    ds_read_b128 v[226:229], v8 offset:3472
    ds_read_b64 v[218:219], v6 offset:736
    ds_read_b64 v[220:221], v6 offset:744
    v_mfma_f32_32x32x16_f16 v[166:181], v[186:189], v[190:193], v[166:181]
    ds_read_b64_tr_b16 a[48:49], v20 offset:24576
    ds_read_b64_tr_b16 a[50:51], v20 offset:25600
    ds_read_b64_tr_b16 a[52:53], v21 offset:24576
    ds_read_b64_tr_b16 a[54:55], v21 offset:25600
    buffer_load_dwordx2 v[36:37], v33, s[8:11], s39 offen offset:16
    s_waitcnt lgkmcnt(14)
    v_mfma_f32_32x32x16_f16 v[150:165], v[198:201], v[206:209], v[150:165]
    ds_read_b64 v[182:183], v5 offset:704
    ds_read_b64 v[184:185], v5 offset:712
    ds_read_b128 v[190:193], v8 offset:880
    v_mfma_f32_32x32x16_f16 v[166:181], v[198:201], v[210:213], v[166:181]
    ds_read_b128 v[194:197], v8 offset:3440
    ds_read_b64 v[186:187], v6 offset:704
    ds_read_b64 v[188:189], v6 offset:712
    v_mfma_f32_32x32x16_f16 v[166:181], v[202:205], v[206:209], v[166:181]
    ds_read_b64_tr_b16 a[56:57], v20 offset:28672
    ds_read_b64_tr_b16 a[58:59], v20 offset:29696
    ds_read_b64_tr_b16 a[60:61], v21 offset:28672
    ds_read_b64_tr_b16 a[62:63], v21 offset:29696
    s_waitcnt lgkmcnt(14)
    v_mfma_f32_32x32x16_f16 v[150:165], v[214:217], v[222:225], v[150:165]
    ds_read_b64 v[198:199], v5 offset:672
    ds_read_b64 v[200:201], v5 offset:680
    ds_read_b128 v[206:209], v8 offset:832
    v_mfma_f32_32x32x16_f16 v[166:181], v[214:217], v[226:229], v[166:181]
    ds_read_b128 v[210:213], v8 offset:3392
    ds_read_b64 v[202:203], v6 offset:672
    ds_read_b64 v[204:205], v6 offset:680
    v_mfma_f32_32x32x16_f16 v[166:181], v[218:221], v[222:225], v[166:181]
    ds_read_b64_tr_b16 a[64:65], v20 offset:32768
    ds_read_b64_tr_b16 a[66:67], v20 offset:33792
    ds_read_b64_tr_b16 a[68:69], v21 offset:32768
    ds_read_b64_tr_b16 a[70:71], v21 offset:33792
    buffer_load_dwordx2 v[38:39], v33, s[8:11], s39 offen offset:32
    s_waitcnt lgkmcnt(14)
    v_mfma_f32_32x32x16_f16 v[150:165], v[182:185], v[190:193], v[150:165]
    ds_read_b64 v[214:215], v5 offset:640
    ds_read_b64 v[216:217], v5 offset:648
    ds_read_b128 v[222:225], v8 offset:800
    v_mfma_f32_32x32x16_f16 v[166:181], v[182:185], v[194:197], v[166:181]
    ds_read_b128 v[226:229], v8 offset:3360
    ds_read_b64 v[218:219], v6 offset:640
    ds_read_b64 v[220:221], v6 offset:648
    v_mfma_f32_32x32x16_f16 v[166:181], v[186:189], v[190:193], v[166:181]
    ds_read_b64_tr_b16 a[72:73], v20 offset:36864
    ds_read_b64_tr_b16 a[74:75], v20 offset:37888
    ds_read_b64_tr_b16 a[76:77], v21 offset:36864
    ds_read_b64_tr_b16 a[78:79], v21 offset:37888
    s_waitcnt vmcnt(6)
    s_lshl_b32 s101, s5, 2
    s_add_u32 s101, s101, s4
    s_lshl_b32 s101, s101, 4
    s_and_b32 s100, s3, 15
    s_add_u32 s101, s101, s100
    s_lshl_b32 s101, s101, 3
    s_add_u32 s100, s101, 12591104
    v_mov_b32 v16, s100
    v_mov_b32 v17, s46
    s_mov_b64 exec, 1
    buffer_store_dword v17, v16, s[20:23], 0 offen sc1
    s_mov_b64 exec, -1
    s_waitcnt lgkmcnt(14)
    v_mfma_f32_32x32x16_f16 v[150:165], v[198:201], v[206:209], v[150:165]
    ds_read_b64 v[182:183], v5 offset:608
    ds_read_b64 v[184:185], v5 offset:616
    ds_read_b128 v[190:193], v8 offset:752
    v_mfma_f32_32x32x16_f16 v[166:181], v[198:201], v[210:213], v[166:181]
    ds_read_b128 v[194:197], v8 offset:3312
    ds_read_b64 v[186:187], v6 offset:608
    ds_read_b64 v[188:189], v6 offset:616
    v_mfma_f32_32x32x16_f16 v[166:181], v[202:205], v[206:209], v[166:181]
    ds_read_b64_tr_b16 a[80:81], v20 offset:40960
    ds_read_b64_tr_b16 a[82:83], v20 offset:41984
    ds_read_b64_tr_b16 a[84:85], v21 offset:40960
    ds_read_b64_tr_b16 a[86:87], v21 offset:41984
    buffer_load_dwordx2 v[40:41], v33, s[8:11], s39 offen offset:48
    s_waitcnt lgkmcnt(14)
    v_mfma_f32_32x32x16_f16 v[150:165], v[214:217], v[222:225], v[150:165]
    ds_read_b64 v[198:199], v5 offset:576
    ds_read_b64 v[200:201], v5 offset:584
    ds_read_b128 v[206:209], v8 offset:720
    v_mfma_f32_32x32x16_f16 v[166:181], v[214:217], v[226:229], v[166:181]
    ds_read_b128 v[210:213], v8 offset:3280
    ds_read_b64 v[202:203], v6 offset:576
    ds_read_b64 v[204:205], v6 offset:584
    v_mfma_f32_32x32x16_f16 v[166:181], v[218:221], v[222:225], v[166:181]
    ds_read_b64_tr_b16 a[88:89], v20 offset:45056
    ds_read_b64_tr_b16 a[90:91], v20 offset:46080
    ds_read_b64_tr_b16 a[92:93], v21 offset:45056
    ds_read_b64_tr_b16 a[94:95], v21 offset:46080
    s_waitcnt lgkmcnt(14)
    v_mfma_f32_32x32x16_f16 v[150:165], v[182:185], v[190:193], v[150:165]
    ds_read_b64 v[214:215], v5 offset:544
    ds_read_b64 v[216:217], v5 offset:552
    ds_read_b128 v[222:225], v8 offset:672
    v_mfma_f32_32x32x16_f16 v[166:181], v[182:185], v[194:197], v[166:181]
    ds_read_b128 v[226:229], v8 offset:3232
    ds_read_b64 v[218:219], v6 offset:544
    ds_read_b64 v[220:221], v6 offset:552
    v_mfma_f32_32x32x16_f16 v[166:181], v[186:189], v[190:193], v[166:181]
    ds_read_b64_tr_b16 a[96:97], v20 offset:49152
    ds_read_b64_tr_b16 a[98:99], v20 offset:50176
    ds_read_b64_tr_b16 a[100:101], v21 offset:49152
    ds_read_b64_tr_b16 a[102:103], v21 offset:50176
    s_waitcnt lgkmcnt(14)
    v_mfma_f32_32x32x16_f16 v[150:165], v[198:201], v[206:209], v[150:165]
    ds_read_b64 v[182:183], v5 offset:512
    ds_read_b64 v[184:185], v5 offset:520
    ds_read_b128 v[190:193], v8 offset:640
    v_mfma_f32_32x32x16_f16 v[166:181], v[198:201], v[210:213], v[166:181]
    ds_read_b128 v[194:197], v8 offset:3200
    ds_read_b64 v[186:187], v6 offset:512
    ds_read_b64 v[188:189], v6 offset:520
    v_mfma_f32_32x32x16_f16 v[166:181], v[202:205], v[206:209], v[166:181]
    ds_read_b64_tr_b16 a[104:105], v20 offset:53248
    ds_read_b64_tr_b16 a[106:107], v20 offset:54272
    ds_read_b64_tr_b16 a[108:109], v21 offset:53248
    ds_read_b64_tr_b16 a[110:111], v21 offset:54272
    s_waitcnt lgkmcnt(14)
    v_mfma_f32_32x32x16_f16 v[150:165], v[214:217], v[222:225], v[150:165]
    ds_read_b64 v[198:199], v5 offset:480
    ds_read_b64 v[200:201], v5 offset:488
    ds_read_b128 v[206:209], v8 offset:592
    v_mfma_f32_32x32x16_f16 v[166:181], v[214:217], v[226:229], v[166:181]
    ds_read_b128 v[210:213], v8 offset:3152
    ds_read_b64 v[202:203], v6 offset:480
    ds_read_b64 v[204:205], v6 offset:488
    v_mfma_f32_32x32x16_f16 v[166:181], v[218:221], v[222:225], v[166:181]
    ds_read_b64_tr_b16 a[112:113], v20 offset:57344
    ds_read_b64_tr_b16 a[114:115], v20 offset:58368
    ds_read_b64_tr_b16 a[116:117], v21 offset:57344
    ds_read_b64_tr_b16 a[118:119], v21 offset:58368
    s_waitcnt lgkmcnt(14)
    v_mfma_f32_32x32x16_f16 v[150:165], v[182:185], v[190:193], v[150:165]
    ds_read_b64 v[214:215], v5 offset:448
    ds_read_b64 v[216:217], v5 offset:456
    ds_read_b128 v[222:225], v8 offset:560
    v_mfma_f32_32x32x16_f16 v[166:181], v[182:185], v[194:197], v[166:181]
    ds_read_b128 v[226:229], v8 offset:3120
    ds_read_b64 v[218:219], v6 offset:448
    ds_read_b64 v[220:221], v6 offset:456
    v_mfma_f32_32x32x16_f16 v[166:181], v[186:189], v[190:193], v[166:181]
    ds_read_b64_tr_b16 a[120:121], v20 offset:61440
    ds_read_b64_tr_b16 a[122:123], v20 offset:62464
    ds_read_b64_tr_b16 a[124:125], v21 offset:61440
    ds_read_b64_tr_b16 a[126:127], v21 offset:62464
    s_waitcnt lgkmcnt(0)
    s_barrier
    v_mfma_f32_32x32x16_f16 v[150:165], v[198:201], v[206:209], v[150:165]
    ds_read_b64 v[182:183], v5 offset:416
    ds_read_b64 v[184:185], v5 offset:424
    ds_read_b128 v[190:193], v8 offset:512
    v_mfma_f32_32x32x16_f16 v[166:181], v[198:201], v[210:213], v[166:181]
    ds_read_b128 v[194:197], v8 offset:3072
    ds_read_b64 v[186:187], v6 offset:416
    ds_read_b64 v[188:189], v6 offset:424
    v_mfma_f32_32x32x16_f16 v[166:181], v[202:205], v[206:209], v[166:181]
    s_add_u32 m0, s42, 0
    s_add_u32 s97, s41, 393216
    buffer_load_dwordx4 v19, s[16:19], s97 offen lds
    s_add_u32 m0, s42, 4096
    s_add_u32 s97, s41, 409600
    buffer_load_dwordx4 v19, s[16:19], s97 offen lds
    v_mfma_f32_32x32x16_f16 v[150:165], v[214:217], v[222:225], v[150:165]
    ds_read_b64 v[198:199], v5 offset:384
    ds_read_b64 v[200:201], v5 offset:392
    ds_read_b128 v[206:209], v8 offset:480
    v_mfma_f32_32x32x16_f16 v[166:181], v[214:217], v[226:229], v[166:181]
    ds_read_b128 v[210:213], v8 offset:3040
    ds_read_b64 v[202:203], v6 offset:384
    ds_read_b64 v[204:205], v6 offset:392
    v_mfma_f32_32x32x16_f16 v[166:181], v[218:221], v[222:225], v[166:181]
    s_add_u32 m0, s42, 8192
    s_add_u32 s97, s41, 425984
    buffer_load_dwordx4 v19, s[16:19], s97 offen lds
    s_waitcnt lgkmcnt(9)
    v_mfma_f32_32x32x16_f16 v[150:165], v[182:185], v[190:193], v[150:165]
    ds_read_b64 v[214:215], v5 offset:352
    ds_read_b64 v[216:217], v5 offset:360
    ds_read_b128 v[222:225], v8 offset:432
    s_waitcnt lgkmcnt(11)
    v_mfma_f32_32x32x16_f16 v[166:181], v[182:185], v[194:197], v[166:181]
    ds_read_b128 v[226:229], v8 offset:2992
    ds_read_b64 v[218:219], v6 offset:352
    ds_read_b64 v[220:221], v6 offset:360
    s_waitcnt lgkmcnt(12)
    v_mfma_f32_32x32x16_f16 v[166:181], v[186:189], v[190:193], v[166:181]
    s_add_u32 m0, s42, 12288
    s_add_u32 s97, s41, 442368
    buffer_load_dwordx4 v19, s[16:19], s97 offen lds
    s_waitcnt lgkmcnt(9)
    v_mfma_f32_32x32x16_f16 v[150:165], v[198:201], v[206:209], v[150:165]
    ds_read_b64 v[182:183], v5 offset:320
    ds_read_b64 v[184:185], v5 offset:328
    ds_read_b128 v[190:193], v8 offset:400
    s_waitcnt lgkmcnt(11)
    v_mfma_f32_32x32x16_f16 v[166:181], v[198:201], v[210:213], v[166:181]
    ds_read_b128 v[194:197], v8 offset:2960
    ds_read_b64 v[186:187], v6 offset:320
    ds_read_b64 v[188:189], v6 offset:328
    s_waitcnt lgkmcnt(12)
    v_mfma_f32_32x32x16_f16 v[166:181], v[202:205], v[206:209], v[166:181]
    s_add_u32 m0, s42, 16384
    s_add_u32 s97, s41, 458752
    buffer_load_dwordx4 v19, s[16:19], s97 offen lds
    s_add_u32 m0, s42, 20480
    s_add_u32 s97, s41, 475136
    buffer_load_dwordx4 v19, s[16:19], s97 offen lds
    s_waitcnt lgkmcnt(9)
    v_mfma_f32_32x32x16_f16 v[150:165], v[214:217], v[222:225], v[150:165]
    ds_read_b64 v[198:199], v5 offset:288
    ds_read_b64 v[200:201], v5 offset:296
    ds_read_b128 v[206:209], v8 offset:352
    s_waitcnt lgkmcnt(11)
    v_mfma_f32_32x32x16_f16 v[166:181], v[214:217], v[226:229], v[166:181]
    ds_read_b128 v[210:213], v8 offset:2912
    ds_read_b64 v[202:203], v6 offset:288
    ds_read_b64 v[204:205], v6 offset:296
    s_waitcnt lgkmcnt(12)
    v_mfma_f32_32x32x16_f16 v[166:181], v[218:221], v[222:225], v[166:181]
    s_add_u32 m0, s42, 24576
    s_add_u32 s97, s41, 491520
    buffer_load_dwordx4 v19, s[16:19], s97 offen lds
    s_waitcnt lgkmcnt(9)
    v_mfma_f32_32x32x16_f16 v[150:165], v[182:185], v[190:193], v[150:165]
    ds_read_b64 v[214:215], v5 offset:256
    ds_read_b64 v[216:217], v5 offset:264
    ds_read_b128 v[222:225], v8 offset:320
    s_waitcnt lgkmcnt(11)
    v_mfma_f32_32x32x16_f16 v[166:181], v[182:185], v[194:197], v[166:181]
    ds_read_b128 v[226:229], v8 offset:2880
    ds_read_b64 v[218:219], v6 offset:256
    ds_read_b64 v[220:221], v6 offset:264
    s_waitcnt lgkmcnt(12)
    v_mfma_f32_32x32x16_f16 v[166:181], v[186:189], v[190:193], v[166:181]
    s_add_u32 m0, s42, 28672
    s_add_u32 s97, s41, 507904
    buffer_load_dwordx4 v19, s[16:19], s97 offen lds
    s_waitcnt lgkmcnt(9)
    v_mfma_f32_32x32x16_f16 v[150:165], v[198:201], v[206:209], v[150:165]
    ds_read_b64 v[182:183], v5 offset:224
    ds_read_b64 v[184:185], v5 offset:232
    ds_read_b128 v[190:193], v8 offset:272
    s_waitcnt lgkmcnt(11)
    v_mfma_f32_32x32x16_f16 v[166:181], v[198:201], v[210:213], v[166:181]
    ds_read_b128 v[194:197], v8 offset:2832
    ds_read_b64 v[186:187], v6 offset:224
    ds_read_b64 v[188:189], v6 offset:232
    s_waitcnt lgkmcnt(12)
    v_mfma_f32_32x32x16_f16 v[166:181], v[202:205], v[206:209], v[166:181]
    s_add_u32 m0, s42, 32768
    s_add_u32 s97, s41, 524288
    buffer_load_dwordx4 v19, s[16:19], s97 offen lds
    s_add_u32 m0, s42, 36864
    s_add_u32 s97, s41, 540672
    buffer_load_dwordx4 v19, s[16:19], s97 offen lds
    s_waitcnt lgkmcnt(9)
    v_mfma_f32_32x32x16_f16 v[150:165], v[214:217], v[222:225], v[150:165]
    ds_read_b64 v[198:199], v5 offset:192
    ds_read_b64 v[200:201], v5 offset:200
    ds_read_b128 v[206:209], v8 offset:240
    s_waitcnt lgkmcnt(11)
    v_mfma_f32_32x32x16_f16 v[166:181], v[214:217], v[226:229], v[166:181]
    ds_read_b128 v[210:213], v8 offset:2800
    ds_read_b64 v[202:203], v6 offset:192
    ds_read_b64 v[204:205], v6 offset:200
    s_waitcnt lgkmcnt(12)
    v_mfma_f32_32x32x16_f16 v[166:181], v[218:221], v[222:225], v[166:181]
    s_add_u32 m0, s42, 40960
    s_add_u32 s97, s41, 557056
    buffer_load_dwordx4 v19, s[16:19], s97 offen lds
    s_waitcnt lgkmcnt(9)
    v_mfma_f32_32x32x16_f16 v[150:165], v[182:185], v[190:193], v[150:165]
    ds_read_b64 v[214:215], v5 offset:160
    ds_read_b64 v[216:217], v5 offset:168
    ds_read_b128 v[222:225], v8 offset:192
    s_waitcnt lgkmcnt(11)
    v_mfma_f32_32x32x16_f16 v[166:181], v[182:185], v[194:197], v[166:181]
    ds_read_b128 v[226:229], v8 offset:2752
    ds_read_b64 v[218:219], v6 offset:160
    ds_read_b64 v[220:221], v6 offset:168
    s_waitcnt lgkmcnt(12)
    v_mfma_f32_32x32x16_f16 v[166:181], v[186:189], v[190:193], v[166:181]
    s_add_u32 m0, s42, 45056
    s_add_u32 s97, s41, 573440
    buffer_load_dwordx4 v19, s[16:19], s97 offen lds
    s_waitcnt lgkmcnt(9)
    v_mfma_f32_32x32x16_f16 v[150:165], v[198:201], v[206:209], v[150:165]
    ds_read_b64 v[182:183], v5 offset:128
    ds_read_b64 v[184:185], v5 offset:136
    ds_read_b128 v[190:193], v8 offset:160
    s_waitcnt lgkmcnt(11)
    v_mfma_f32_32x32x16_f16 v[166:181], v[198:201], v[210:213], v[166:181]
    ds_read_b128 v[194:197], v8 offset:2720
    ds_read_b64 v[186:187], v6 offset:128
    ds_read_b64 v[188:189], v6 offset:136
    s_waitcnt lgkmcnt(12)
    v_mfma_f32_32x32x16_f16 v[166:181], v[202:205], v[206:209], v[166:181]
    s_add_u32 m0, s42, 49152
    s_add_u32 s97, s41, 589824
    buffer_load_dwordx4 v19, s[16:19], s97 offen lds
    s_add_u32 m0, s42, 53248
    s_add_u32 s97, s41, 606208
    buffer_load_dwordx4 v19, s[16:19], s97 offen lds
    s_waitcnt lgkmcnt(9)
    v_mfma_f32_32x32x16_f16 v[150:165], v[214:217], v[222:225], v[150:165]
    ds_read_b64 v[198:199], v5 offset:96
    ds_read_b64 v[200:201], v5 offset:104
    ds_read_b128 v[206:209], v8 offset:112
    s_waitcnt lgkmcnt(11)
    v_mfma_f32_32x32x16_f16 v[166:181], v[214:217], v[226:229], v[166:181]
    ds_read_b128 v[210:213], v8 offset:2672
    ds_read_b64 v[202:203], v6 offset:96
    ds_read_b64 v[204:205], v6 offset:104
    s_waitcnt lgkmcnt(12)
    v_mfma_f32_32x32x16_f16 v[166:181], v[218:221], v[222:225], v[166:181]
    s_add_u32 m0, s42, 57344
    s_add_u32 s97, s41, 622592
    buffer_load_dwordx4 v19, s[16:19], s97 offen lds
    s_waitcnt lgkmcnt(9)
    v_mfma_f32_32x32x16_f16 v[150:165], v[182:185], v[190:193], v[150:165]
    ds_read_b64 v[214:215], v5 offset:64
    ds_read_b64 v[216:217], v5 offset:72
    ds_read_b128 v[222:225], v8 offset:80
    s_waitcnt lgkmcnt(11)
    v_mfma_f32_32x32x16_f16 v[166:181], v[182:185], v[194:197], v[166:181]
    ds_read_b128 v[226:229], v8 offset:2640
    ds_read_b64 v[218:219], v6 offset:64
    ds_read_b64 v[220:221], v6 offset:72
    s_waitcnt lgkmcnt(12)
    v_mfma_f32_32x32x16_f16 v[166:181], v[186:189], v[190:193], v[166:181]
    s_add_u32 m0, s42, 61440
    s_add_u32 s97, s41, 638976
    buffer_load_dwordx4 v19, s[16:19], s97 offen lds
    s_waitcnt lgkmcnt(9)
    v_mfma_f32_32x32x16_f16 v[150:165], v[198:201], v[206:209], v[150:165]
    ds_read_b64 v[182:183], v5 offset:32
    ds_read_b64 v[184:185], v5 offset:40
    ds_read_b128 v[190:193], v8 offset:32
    s_waitcnt lgkmcnt(11)
    v_mfma_f32_32x32x16_f16 v[166:181], v[198:201], v[210:213], v[166:181]
    ds_read_b128 v[194:197], v8 offset:2592
    ds_read_b64 v[186:187], v6 offset:32
    ds_read_b64 v[188:189], v6 offset:40
    s_waitcnt lgkmcnt(12)
    v_mfma_f32_32x32x16_f16 v[166:181], v[202:205], v[206:209], v[166:181]
    s_waitcnt lgkmcnt(9)
    v_mfma_f32_32x32x16_f16 v[150:165], v[214:217], v[222:225], v[150:165]
    ds_read_b64 v[198:199], v5 offset:0
    ds_read_b64 v[200:201], v5 offset:8
    ds_read_b128 v[206:209], v8 offset:0
    s_waitcnt lgkmcnt(11)
    v_mfma_f32_32x32x16_f16 v[166:181], v[214:217], v[226:229], v[166:181]
    ds_read_b128 v[210:213], v8 offset:2560
    ds_read_b64 v[202:203], v6 offset:0
    ds_read_b64 v[204:205], v6 offset:8
    s_waitcnt lgkmcnt(12)
    v_mfma_f32_32x32x16_f16 v[166:181], v[218:221], v[222:225], v[166:181]
    s_waitcnt lgkmcnt(9)
    v_mfma_f32_32x32x16_f16 v[150:165], v[182:185], v[190:193], v[150:165]
    s_waitcnt lgkmcnt(8)
    v_mfma_f32_32x32x16_f16 v[166:181], v[182:185], v[194:197], v[166:181]
    s_waitcnt lgkmcnt(6)
    v_mfma_f32_32x32x16_f16 v[166:181], v[186:189], v[190:193], v[166:181]
    s_waitcnt lgkmcnt(3)
    v_mfma_f32_32x32x16_f16 v[150:165], v[198:201], v[206:209], v[150:165]
    s_waitcnt lgkmcnt(2)
    v_mfma_f32_32x32x16_f16 v[166:181], v[198:201], v[210:213], v[166:181]
    s_waitcnt lgkmcnt(0)
    v_mfma_f32_32x32x16_f16 v[166:181], v[202:205], v[206:209], v[166:181]
    s_mov_b32 exec_lo, 0xffff
    s_mov_b32 exec_hi, 0
    buffer_load_dword v5, v26, s[20:23], 0 offen sc1
    s_mov_b64 exec, -1
    s_waitcnt vmcnt(1)
    s_barrier
    s_cmp_eq_u32 s33, 0
    s_cbranch_scc0 L_cr0_18
    s_nop 3
    ds_write_b128 v10, v[166:169] offset:0
    ds_write_b128 v10, v[170:173] offset:1024
    ds_write_b128 v10, v[174:177] offset:2048
    ds_write_b128 v10, v[178:181] offset:3072
    s_branch L_cr1_19
L_cr0_18:
    ds_write_b128 v10, v[150:153] offset:0
    ds_write_b128 v10, v[154:157] offset:1024
    ds_write_b128 v10, v[158:161] offset:2048
    ds_write_b128 v10, v[162:165] offset:3072
    v_pk_mul_f32 v[150:151], v[166:167], 1.0 op_sel_hi:[1,0]
    v_pk_mul_f32 v[152:153], v[168:169], 1.0 op_sel_hi:[1,0]
    v_pk_mul_f32 v[154:155], v[170:171], 1.0 op_sel_hi:[1,0]
    v_pk_mul_f32 v[156:157], v[172:173], 1.0 op_sel_hi:[1,0]
    v_pk_mul_f32 v[158:159], v[174:175], 1.0 op_sel_hi:[1,0]
    v_pk_mul_f32 v[160:161], v[176:177], 1.0 op_sel_hi:[1,0]
    v_pk_mul_f32 v[162:163], v[178:179], 1.0 op_sel_hi:[1,0]
    v_pk_mul_f32 v[164:165], v[180:181], 1.0 op_sel_hi:[1,0]
L_cr1_19:
    ds_read_b64 v[46:47], v12 offset:0
    ds_read_b64 v[48:49], v12 offset:16
    ds_read_b64 v[50:51], v12 offset:32
    ds_read_b64 v[52:53], v12 offset:48
    s_mov_b32 s38, 0
    s_mov_b32 exec_lo, 0xffff
    s_mov_b32 exec_hi, 0
L_Bc_21:
    s_waitcnt vmcnt(0)
    v_cmp_ne_u32 vcc, s46, v5
    s_nop 0
    s_cmp_eq_u64 vcc, 0
    s_cbranch_scc1 L_Bd_22
    s_add_u32 s38, s38, 1
    s_cmp_lt_u32 s38, 0x40000
    s_cbranch_scc0 L_B_20
    buffer_load_dword v5, v26, s[20:23], 0 offen sc1
    s_waitcnt vmcnt(0)
    s_branch L_Bc_21
L_B_20:
    v_mov_b32 v8, 0
    v_mov_b32 v9, 0xdead
    global_store_dword v8, v9, s[92:93]
L_Bd_22:
    s_mov_b64 exec, -1
    s_lshl_b32 s43, s47, 1
    s_add_u32 s43, s43, s33
    s_mul_i32 s43, s43, 88064
    s_mul_i32 s98, s32, 44032
    s_add_u32 s43, s43, s98
    s_add_u32 s43, s43, 4194304
    buffer_load_dwordx4 v[198:201], v2, s[20:23], s43 offen offset:0 sc1
    buffer_load_dwordx4 v[202:205], v2, s[20:23], s43 offen offset:1024 sc1
    buffer_load_dwordx4 v[206:209], v2, s[20:23], s43 offen offset:2048 sc1
    buffer_load_dwordx4 v[210:213], v2, s[20:23], s43 offen offset:3072 sc1
    s_add_u32 s43, s43, 4096
    buffer_load_dwordx4 v[214:217], v2, s[20:23], s43 offen offset:0 sc1
    buffer_load_dwordx4 v[218:221], v2, s[20:23], s43 offen offset:1024 sc1
    buffer_load_dwordx4 v[222:225], v2, s[20:23], s43 offen offset:2048 sc1
    buffer_load_dwordx4 v[226:229], v2, s[20:23], s43 offen offset:3072 sc1
    s_add_u32 s43, s43, 4096
    buffer_load_dwordx4 v[230:233], v2, s[20:23], s43 offen offset:0 sc1
    buffer_load_dwordx4 v[234:237], v2, s[20:23], s43 offen offset:1024 sc1
    s_waitcnt lgkmcnt(0)
    s_barrier
    ds_read_b128 v[182:185], v11 offset:0
    ds_read_b128 v[186:189], v11 offset:1024
    ds_read_b128 v[190:193], v11 offset:2048
    ds_read_b128 v[194:197], v11 offset:3072
    s_mov_b32 s34, s44
    s_waitcnt lgkmcnt(3)
    v_pk_add_f32 v[150:151], v[150:151], v[182:183]
    v_pk_add_f32 v[152:153], v[152:153], v[184:185]
    s_waitcnt lgkmcnt(2)
    v_pk_add_f32 v[154:155], v[154:155], v[186:187]
    v_pk_add_f32 v[156:157], v[156:157], v[188:189]
    s_waitcnt lgkmcnt(1)
    v_pk_add_f32 v[158:159], v[158:159], v[190:191]
    v_pk_add_f32 v[160:161], v[160:161], v[192:193]
    s_waitcnt lgkmcnt(0)
    v_pk_add_f32 v[162:163], v[162:163], v[194:195]
    v_pk_add_f32 v[164:165], v[164:165], v[196:197]
    v_pk_mul_f32 v[150:151], v[150:151], s[34:35] op_sel_hi:[1,0]
    v_pk_mul_f32 v[152:153], v[152:153], s[34:35] op_sel_hi:[1,0]
    v_pk_mul_f32 v[154:155], v[154:155], s[34:35] op_sel_hi:[1,0]
    v_pk_mul_f32 v[156:157], v[156:157], s[34:35] op_sel_hi:[1,0]
    v_pk_mul_f32 v[158:159], v[158:159], s[34:35] op_sel_hi:[1,0]
    v_pk_mul_f32 v[160:161], v[160:161], s[34:35] op_sel_hi:[1,0]
    v_pk_mul_f32 v[162:163], v[162:163], s[34:35] op_sel_hi:[1,0]
    v_pk_mul_f32 v[164:165], v[164:165], s[34:35] op_sel_hi:[1,0]
    v_fma_mix_f32 v150, v46, s45, v150 op_sel:[0,0,0] op_sel_hi:[1,0,0]
    v_fma_mix_f32 v151, v46, s45, v151 op_sel:[1,0,0] op_sel_hi:[1,0,0]
    v_fma_mix_f32 v152, v47, s45, v152 op_sel:[0,0,0] op_sel_hi:[1,0,0]
    v_fma_mix_f32 v153, v47, s45, v153 op_sel:[1,0,0] op_sel_hi:[1,0,0]
    v_fma_mix_f32 v154, v48, s45, v154 op_sel:[0,0,0] op_sel_hi:[1,0,0]
    v_fma_mix_f32 v155, v48, s45, v155 op_sel:[1,0,0] op_sel_hi:[1,0,0]
    v_fma_mix_f32 v156, v49, s45, v156 op_sel:[0,0,0] op_sel_hi:[1,0,0]
    v_fma_mix_f32 v157, v49, s45, v157 op_sel:[1,0,0] op_sel_hi:[1,0,0]
    v_fma_mix_f32 v158, v50, s45, v158 op_sel:[0,0,0] op_sel_hi:[1,0,0]
    v_fma_mix_f32 v159, v50, s45, v159 op_sel:[1,0,0] op_sel_hi:[1,0,0]
    v_fma_mix_f32 v160, v51, s45, v160 op_sel:[0,0,0] op_sel_hi:[1,0,0]
    v_fma_mix_f32 v161, v51, s45, v161 op_sel:[1,0,0] op_sel_hi:[1,0,0]
    v_fma_mix_f32 v162, v52, s45, v162 op_sel:[0,0,0] op_sel_hi:[1,0,0]
    v_fma_mix_f32 v163, v52, s45, v163 op_sel:[1,0,0] op_sel_hi:[1,0,0]
    v_fma_mix_f32 v164, v53, s45, v164 op_sel:[0,0,0] op_sel_hi:[1,0,0]
    v_fma_mix_f32 v165, v53, s45, v165 op_sel:[1,0,0] op_sel_hi:[1,0,0]
    v_cvt_pk_bf16_f32 v182, v150, v151
    v_cvt_pk_bf16_f32 v183, v152, v153
    v_cvt_pk_bf16_f32 v184, v154, v155
    v_cvt_pk_bf16_f32 v185, v156, v157
    v_cvt_pk_bf16_f32 v186, v158, v159
    v_cvt_pk_bf16_f32 v187, v160, v161
    v_cvt_pk_bf16_f32 v188, v162, v163
    v_cvt_pk_bf16_f32 v189, v164, v165
    v_xor_b32 v6, 0, v14
    v_add_u32 v6, v6, v13
    ds_write_b64 v6, v[182:183]
    v_xor_b32 v6, 16, v14
    v_add_u32 v6, v6, v13
    ds_write_b64 v6, v[184:185]
    v_xor_b32 v6, 32, v14
    v_add_u32 v6, v6, v13
    ds_write_b64 v6, v[186:187]
    v_xor_b32 v6, 48, v14
    v_add_u32 v6, v6, v13
    ds_write_b64 v6, v[188:189]
    ds_read_b128 v[190:193], v15
    ds_read_b128 v[194:197], v15 offset:1024
    s_lshl_b32 s58, s3, 1
    s_add_u32 s58, s58, s32
    s_lshl_b32 s58, s58, 12
    s_lshl_b32 s59, s33, 11
    s_add_u32 s58, s58, s59
    s_add_u32 s58, s58, 10485760
    s_waitcnt lgkmcnt(1)
    buffer_store_dwordx4 v[190:193], v2, s[20:23], s58 offen sc1
    s_waitcnt lgkmcnt(0)
    buffer_store_dwordx4 v[194:197], v2, s[20:23], s58 offen offset:1024 sc1
    buffer_load_dwordx4 v[238:241], v2, s[20:23], s43 offen offset:2048 sc1
    s_waitcnt vmcnt(12)
    v_mfma_f32_32x32x16_bf16 v[150:165], a[0:3], v[198:201], 0
    ds_read_b64_tr_b16 a[128:129], v22 offset:0
    v_mfma_f32_32x32x16_bf16 v[166:181], a[4:7], v[198:201], 0
    ds_read_b64_tr_b16 a[130:131], v22 offset:1024
    ds_read_b64_tr_b16 a[132:133], v23 offset:0
    buffer_load_dwordx4 v[242:245], v2, s[20:23], s43 offen offset:3072 sc1
    s_waitcnt vmcnt(12)
    v_mfma_f32_32x32x16_bf16 v[150:165], a[8:11], v[202:205], v[150:165]
    ds_read_b64_tr_b16 a[134:135], v23 offset:1024
    v_mfma_f32_32x32x16_bf16 v[166:181], a[12:15], v[202:205], v[166:181]
    ds_read_b64_tr_b16 a[136:137], v22 offset:4096
    ds_read_b64_tr_b16 a[138:139], v22 offset:5120
    s_add_u32 s43, s43, 4096
    buffer_load_dwordx4 v[198:201], v2, s[20:23], s43 offen offset:0 sc1
    s_waitcnt vmcnt(12)
    v_mfma_f32_32x32x16_bf16 v[150:165], a[16:19], v[206:209], v[150:165]
    ds_read_b64_tr_b16 a[140:141], v23 offset:4096
    v_mfma_f32_32x32x16_bf16 v[166:181], a[20:23], v[206:209], v[166:181]
    ds_read_b64_tr_b16 a[142:143], v23 offset:5120
    ds_read_b64_tr_b16 a[144:145], v22 offset:8192
    buffer_load_dwordx4 v[202:205], v2, s[20:23], s43 offen offset:1024 sc1
    s_waitcnt vmcnt(12)
    v_mfma_f32_32x32x16_bf16 v[150:165], a[24:27], v[210:213], v[150:165]
    ds_read_b64_tr_b16 a[146:147], v22 offset:9216
    v_mfma_f32_32x32x16_bf16 v[166:181], a[28:31], v[210:213], v[166:181]
    ds_read_b64_tr_b16 a[148:149], v23 offset:8192
    ds_read_b64_tr_b16 a[150:151], v23 offset:9216
    buffer_load_dwordx4 v[206:209], v2, s[20:23], s43 offen offset:2048 sc1
    s_waitcnt vmcnt(12)
    v_mfma_f32_32x32x16_bf16 v[150:165], a[32:35], v[214:217], v[150:165]
    ds_read_b64_tr_b16 a[152:153], v22 offset:12288
    v_mfma_f32_32x32x16_bf16 v[166:181], a[36:39], v[214:217], v[166:181]
    ds_read_b64_tr_b16 a[154:155], v22 offset:13312
    ds_read_b64_tr_b16 a[156:157], v23 offset:12288
    buffer_load_dwordx4 v[210:213], v2, s[20:23], s43 offen offset:3072 sc1
    s_waitcnt vmcnt(12)
    v_mfma_f32_32x32x16_bf16 v[150:165], a[40:43], v[218:221], v[150:165]
    ds_read_b64_tr_b16 a[158:159], v23 offset:13312
    v_mfma_f32_32x32x16_bf16 v[166:181], a[44:47], v[218:221], v[166:181]
    ds_read_b64_tr_b16 a[160:161], v22 offset:16384
    ds_read_b64_tr_b16 a[162:163], v22 offset:17408
    s_waitcnt vmcnt(6)
    s_lshl_b32 s101, s33, 9
    s_lshl_b32 s100, s3, 1
    s_add_u32 s101, s101, s100
    s_add_u32 s101, s101, s32
    s_lshl_b32 s101, s101, 3
    s_add_u32 s100, s101, 12599296
    v_mov_b32 v14, s100
    v_mov_b32 v15, s46
    s_mov_b64 exec, 1
    buffer_store_dword v15, v14, s[20:23], 0 offen sc1
    s_mov_b64 exec, -1
    s_add_u32 s43, s43, 4096
    buffer_load_dwordx4 v[214:217], v2, s[20:23], s43 offen offset:0 sc1
    v_mfma_f32_32x32x16_bf16 v[150:165], a[48:51], v[222:225], v[150:165]
    ds_read_b64_tr_b16 a[164:165], v23 offset:16384
    v_mfma_f32_32x32x16_bf16 v[166:181], a[52:55], v[222:225], v[166:181]
    ds_read_b64_tr_b16 a[166:167], v23 offset:17408
    ds_read_b64_tr_b16 a[168:169], v22 offset:20480
    buffer_load_dwordx4 v[218:221], v2, s[20:23], s43 offen offset:1024 sc1
    v_mfma_f32_32x32x16_bf16 v[150:165], a[56:59], v[226:229], v[150:165]
    ds_read_b64_tr_b16 a[170:171], v22 offset:21504
    v_mfma_f32_32x32x16_bf16 v[166:181], a[60:63], v[226:229], v[166:181]
    ds_read_b64_tr_b16 a[172:173], v23 offset:20480
    ds_read_b64_tr_b16 a[174:175], v23 offset:21504
    buffer_load_dwordx4 v[222:225], v2, s[20:23], s43 offen offset:2048 sc1
    v_mfma_f32_32x32x16_bf16 v[150:165], a[64:67], v[230:233], v[150:165]
    ds_read_b64_tr_b16 a[176:177], v22 offset:24576
    v_mfma_f32_32x32x16_bf16 v[166:181], a[68:71], v[230:233], v[166:181]
    ds_read_b64_tr_b16 a[178:179], v22 offset:25600
    ds_read_b64_tr_b16 a[180:181], v23 offset:24576
    buffer_load_dwordx4 v[226:229], v2, s[20:23], s43 offen offset:3072 sc1
    v_mfma_f32_32x32x16_bf16 v[150:165], a[72:75], v[234:237], v[150:165]
    ds_read_b64_tr_b16 a[182:183], v23 offset:25600
    v_mfma_f32_32x32x16_bf16 v[166:181], a[76:79], v[234:237], v[166:181]
    ds_read_b64_tr_b16 a[184:185], v22 offset:28672
    ds_read_b64_tr_b16 a[186:187], v22 offset:29696
    s_add_u32 s43, s43, 4096
    buffer_load_dwordx4 v[230:233], v2, s[20:23], s43 offen offset:0 sc1
    s_waitcnt vmcnt(11)
    v_mfma_f32_32x32x16_bf16 v[150:165], a[80:83], v[238:241], v[150:165]
    ds_read_b64_tr_b16 a[188:189], v23 offset:28672
    v_mfma_f32_32x32x16_bf16 v[166:181], a[84:87], v[238:241], v[166:181]
    ds_read_b64_tr_b16 a[190:191], v23 offset:29696
    ds_read_b64_tr_b16 a[192:193], v20 offset:0
    buffer_load_dwordx4 v[234:237], v2, s[20:23], s43 offen offset:1024 sc1
    s_waitcnt vmcnt(11)
    v_mfma_f32_32x32x16_bf16 v[150:165], a[88:91], v[242:245], v[150:165]
    ds_read_b64_tr_b16 a[194:195], v20 offset:1024
    v_mfma_f32_32x32x16_bf16 v[166:181], a[92:95], v[242:245], v[166:181]
    ds_read_b64_tr_b16 a[196:197], v21 offset:0
    ds_read_b64_tr_b16 a[198:199], v21 offset:1024
    buffer_load_dwordx4 v[238:241], v2, s[20:23], s43 offen offset:2048 sc1
    s_waitcnt vmcnt(11)
    v_mfma_f32_32x32x16_bf16 v[150:165], a[96:99], v[198:201], v[150:165]
    ds_read_b64_tr_b16 a[200:201], v20 offset:4096
    v_mfma_f32_32x32x16_bf16 v[166:181], a[100:103], v[198:201], v[166:181]
    ds_read_b64_tr_b16 a[202:203], v20 offset:5120
    ds_read_b64_tr_b16 a[204:205], v21 offset:4096
    buffer_load_dwordx4 v[242:245], v2, s[20:23], s43 offen offset:3072 sc1
    s_waitcnt vmcnt(11)
    v_mfma_f32_32x32x16_bf16 v[150:165], a[104:107], v[202:205], v[150:165]
    ds_read_b64_tr_b16 a[206:207], v21 offset:5120
    v_mfma_f32_32x32x16_bf16 v[166:181], a[108:111], v[202:205], v[166:181]
    ds_read_b64_tr_b16 a[208:209], v20 offset:8192
    ds_read_b64_tr_b16 a[210:211], v20 offset:9216
    s_add_u32 s43, s43, 4096
    buffer_load_dwordx4 v[198:201], v2, s[20:23], s43 offen offset:0 sc1
    s_waitcnt vmcnt(11)
    v_mfma_f32_32x32x16_bf16 v[150:165], a[112:115], v[206:209], v[150:165]
    ds_read_b64_tr_b16 a[212:213], v21 offset:8192
    v_mfma_f32_32x32x16_bf16 v[166:181], a[116:119], v[206:209], v[166:181]
    ds_read_b64_tr_b16 a[214:215], v21 offset:9216
    ds_read_b64_tr_b16 a[216:217], v20 offset:12288
    buffer_load_dwordx4 v[202:205], v2, s[20:23], s43 offen offset:1024 sc1
    s_waitcnt vmcnt(11)
    v_mfma_f32_32x32x16_bf16 v[150:165], a[120:123], v[210:213], v[150:165]
    ds_read_b64_tr_b16 a[218:219], v20 offset:13312
    v_mfma_f32_32x32x16_bf16 v[166:181], a[124:127], v[210:213], v[166:181]
    ds_read_b64_tr_b16 a[220:221], v21 offset:12288
    ds_read_b64_tr_b16 a[222:223], v21 offset:13312
    buffer_load_dwordx4 v[206:209], v2, s[20:23], s43 offen offset:2048 sc1
    s_waitcnt vmcnt(10) lgkmcnt(14)
    v_mfma_f32_32x32x16_bf16 v[150:165], a[128:131], v[214:217], v[150:165]
    ds_read_b64_tr_b16 a[224:225], v20 offset:16384
    v_mfma_f32_32x32x16_bf16 v[166:181], a[132:135], v[214:217], v[166:181]
    ds_read_b64_tr_b16 a[226:227], v20 offset:17408
    ds_read_b64_tr_b16 a[228:229], v21 offset:16384
    buffer_load_dwordx4 v[210:213], v2, s[20:23], s43 offen offset:3072 sc1
    s_waitcnt vmcnt(10)
    v_mfma_f32_32x32x16_bf16 v[150:165], a[136:139], v[218:221], v[150:165]
    ds_read_b64_tr_b16 a[230:231], v21 offset:17408
    v_mfma_f32_32x32x16_bf16 v[166:181], a[140:143], v[218:221], v[166:181]
    ds_read_b64_tr_b16 a[232:233], v20 offset:20480
    ds_read_b64_tr_b16 a[234:235], v20 offset:21504
    s_add_u32 s43, s43, 4096
    buffer_load_dwordx4 v[214:217], v2, s[20:23], s43 offen offset:0 sc1
    s_waitcnt vmcnt(10)
    v_mfma_f32_32x32x16_bf16 v[150:165], a[144:147], v[222:225], v[150:165]
    ds_read_b64_tr_b16 a[236:237], v21 offset:20480
    v_mfma_f32_32x32x16_bf16 v[166:181], a[148:151], v[222:225], v[166:181]
    ds_read_b64_tr_b16 a[238:239], v21 offset:21504
    ds_read_b64_tr_b16 a[240:241], v20 offset:24576
    buffer_load_dwordx4 v[218:221], v2, s[20:23], s43 offen offset:1024 sc1
    s_waitcnt vmcnt(10)
    v_mfma_f32_32x32x16_bf16 v[150:165], a[152:155], v[226:229], v[150:165]
    ds_read_b64_tr_b16 a[242:243], v20 offset:25600
    v_mfma_f32_32x32x16_bf16 v[166:181], a[156:159], v[226:229], v[166:181]
    ds_read_b64_tr_b16 a[244:245], v21 offset:24576
    ds_read_b64_tr_b16 a[246:247], v21 offset:25600
    buffer_load_dwordx4 v[222:225], v2, s[20:23], s43 offen offset:2048 sc1
    s_waitcnt vmcnt(10)
    v_mfma_f32_32x32x16_bf16 v[150:165], a[160:163], v[230:233], v[150:165]
    ds_read_b64_tr_b16 a[248:249], v20 offset:28672
    v_mfma_f32_32x32x16_bf16 v[166:181], a[164:167], v[230:233], v[166:181]
    ds_read_b64_tr_b16 a[250:251], v20 offset:29696
    ds_read_b64_tr_b16 a[252:253], v21 offset:28672
    buffer_load_dwordx4 v[226:229], v2, s[20:23], s43 offen offset:3072 sc1
    s_waitcnt vmcnt(10)
    v_mfma_f32_32x32x16_bf16 v[150:165], a[168:171], v[234:237], v[150:165]
    ds_read_b64_tr_b16 a[254:255], v21 offset:29696
    v_mfma_f32_32x32x16_bf16 v[166:181], a[172:175], v[234:237], v[166:181]
    ds_read_b64_tr_b16 v[62:63], v20 offset:32768
    ds_read_b64_tr_b16 v[64:65], v20 offset:33792
    s_add_u32 s43, s43, 4096
    buffer_load_dwordx4 v[230:233], v2, s[20:23], s43 offen offset:0 sc1
    s_waitcnt vmcnt(10)
    v_mfma_f32_32x32x16_bf16 v[150:165], a[176:179], v[238:241], v[150:165]
    ds_read_b64_tr_b16 v[66:67], v21 offset:32768
    v_mfma_f32_32x32x16_bf16 v[166:181], a[180:183], v[238:241], v[166:181]
    ds_read_b64_tr_b16 v[68:69], v21 offset:33792
    ds_read_b64_tr_b16 v[70:71], v20 offset:36864
    buffer_load_dwordx4 v[234:237], v2, s[20:23], s43 offen offset:1024 sc1
    s_waitcnt vmcnt(10)
    v_mfma_f32_32x32x16_bf16 v[150:165], a[184:187], v[242:245], v[150:165]
    ds_read_b64_tr_b16 v[72:73], v20 offset:37888
    v_mfma_f32_32x32x16_bf16 v[166:181], a[188:191], v[242:245], v[166:181]
    ds_read_b64_tr_b16 v[74:75], v21 offset:36864
    ds_read_b64_tr_b16 v[76:77], v21 offset:37888
    buffer_load_dwordx4 v[238:241], v2, s[20:23], s43 offen offset:2048 sc1
    s_waitcnt vmcnt(10)
    v_mfma_f32_32x32x16_bf16 v[150:165], a[192:195], v[198:201], v[150:165]
    ds_read_b64_tr_b16 v[78:79], v20 offset:40960
    s_waitcnt lgkmcnt(14)
    v_mfma_f32_32x32x16_bf16 v[166:181], a[196:199], v[198:201], v[166:181]
    ds_read_b64_tr_b16 v[80:81], v20 offset:41984
    ds_read_b64_tr_b16 v[82:83], v21 offset:40960
    buffer_load_dwordx4 v[242:245], v2, s[20:23], s43 offen offset:3072 sc1
    s_waitcnt vmcnt(10)
    v_mfma_f32_32x32x16_bf16 v[150:165], a[200:203], v[202:205], v[150:165]
    ds_read_b64_tr_b16 v[84:85], v21 offset:41984
    v_mfma_f32_32x32x16_bf16 v[166:181], a[204:207], v[202:205], v[166:181]
    ds_read_b64_tr_b16 v[86:87], v20 offset:45056
    ds_read_b64_tr_b16 v[88:89], v20 offset:46080
    s_add_u32 s43, s43, 4096
    buffer_load_dwordx4 v[198:201], v2, s[20:23], s43 offen offset:0 sc1
    s_waitcnt vmcnt(10)
    v_mfma_f32_32x32x16_bf16 v[150:165], a[208:211], v[206:209], v[150:165]
    ds_read_b64_tr_b16 v[90:91], v21 offset:45056
    v_mfma_f32_32x32x16_bf16 v[166:181], a[212:215], v[206:209], v[166:181]
    ds_read_b64_tr_b16 v[92:93], v21 offset:46080
    ds_read_b64_tr_b16 v[94:95], v20 offset:49152
    buffer_load_dwordx4 v[202:205], v2, s[20:23], s43 offen offset:1024 sc1
    s_waitcnt vmcnt(10)
    v_mfma_f32_32x32x16_bf16 v[150:165], a[216:219], v[210:213], v[150:165]
    ds_read_b64_tr_b16 v[96:97], v20 offset:50176
    v_mfma_f32_32x32x16_bf16 v[166:181], a[220:223], v[210:213], v[166:181]
    ds_read_b64_tr_b16 v[98:99], v21 offset:49152
    ds_read_b64_tr_b16 v[100:101], v21 offset:50176
    buffer_load_dwordx4 v[206:209], v2, s[20:23], s43 offen offset:2048 sc1
    s_waitcnt vmcnt(10)
    v_mfma_f32_32x32x16_bf16 v[150:165], a[224:227], v[214:217], v[150:165]
    ds_read_b64_tr_b16 v[102:103], v20 offset:53248
    v_mfma_f32_32x32x16_bf16 v[166:181], a[228:231], v[214:217], v[166:181]
    ds_read_b64_tr_b16 v[104:105], v20 offset:54272
    ds_read_b64_tr_b16 v[106:107], v21 offset:53248
    buffer_load_dwordx4 v[210:213], v2, s[20:23], s43 offen offset:3072 sc1
    s_waitcnt vmcnt(10)
    v_mfma_f32_32x32x16_bf16 v[150:165], a[232:235], v[218:221], v[150:165]
    ds_read_b64_tr_b16 v[108:109], v21 offset:54272
    v_mfma_f32_32x32x16_bf16 v[166:181], a[236:239], v[218:221], v[166:181]
    ds_read_b64_tr_b16 v[110:111], v20 offset:57344
    ds_read_b64_tr_b16 v[112:113], v20 offset:58368
    s_add_u32 s43, s43, 4096
    buffer_load_dwordx4 v[214:217], v2, s[20:23], s43 offen offset:0 sc1
    s_waitcnt vmcnt(10)
    v_mfma_f32_32x32x16_bf16 v[150:165], a[240:243], v[222:225], v[150:165]
    ds_read_b64_tr_b16 v[114:115], v21 offset:57344
    s_waitcnt lgkmcnt(14)
    v_mfma_f32_32x32x16_bf16 v[166:181], a[244:247], v[222:225], v[166:181]
    ds_read_b64_tr_b16 v[116:117], v21 offset:58368
    ds_read_b64_tr_b16 v[118:119], v20 offset:61440
    buffer_load_dwordx4 v[218:221], v2, s[20:23], s43 offen offset:1024 sc1
    s_waitcnt vmcnt(10)
    v_mfma_f32_32x32x16_bf16 v[150:165], a[248:251], v[226:229], v[150:165]
    ds_read_b64_tr_b16 v[120:121], v20 offset:62464
    v_mfma_f32_32x32x16_bf16 v[166:181], a[252:255], v[226:229], v[166:181]
    ds_read_b64_tr_b16 v[122:123], v21 offset:61440
    ds_read_b64_tr_b16 v[124:125], v21 offset:62464
    buffer_load_dwordx4 v[222:225], v2, s[20:23], s43 offen offset:2048 sc1
    s_waitcnt vmcnt(10)
    v_mfma_f32_32x32x16_bf16 v[150:165], v[62:65], v[230:233], v[150:165]
    ds_read_b64_tr_b16 v[126:127], v24 offset:0
    v_mfma_f32_32x32x16_bf16 v[166:181], v[66:69], v[230:233], v[166:181]
    ds_read_b64_tr_b16 v[128:129], v24 offset:1024
    ds_read_b64_tr_b16 v[130:131], v25 offset:0
    s_waitcnt vmcnt(9)
    v_mfma_f32_32x32x16_bf16 v[150:165], v[70:73], v[234:237], v[150:165]
    ds_read_b64_tr_b16 v[132:133], v25 offset:1024
    v_mfma_f32_32x32x16_bf16 v[166:181], v[74:77], v[234:237], v[166:181]
    ds_read_b64_tr_b16 v[134:135], v24 offset:4096
    ds_read_b64_tr_b16 v[136:137], v24 offset:5120
    buffer_load_dword v5, v27, s[20:23], 0 offen sc1
    s_waitcnt vmcnt(9)
    v_mfma_f32_32x32x16_bf16 v[150:165], v[78:81], v[238:241], v[150:165]
    ds_read_b64_tr_b16 v[138:139], v25 offset:4096
    v_mfma_f32_32x32x16_bf16 v[166:181], v[82:85], v[238:241], v[166:181]
    ds_read_b64_tr_b16 v[140:141], v25 offset:5120
    ds_read_b64_tr_b16 v[142:143], v24 offset:8192
    s_waitcnt vmcnt(8) lgkmcnt(14)
    v_mfma_f32_32x32x16_bf16 v[150:165], v[86:89], v[242:245], v[150:165]
    ds_read_b64_tr_b16 v[144:145], v24 offset:9216
    v_mfma_f32_32x32x16_bf16 v[166:181], v[90:93], v[242:245], v[166:181]
    ds_read_b64_tr_b16 v[146:147], v25 offset:8192
    ds_read_b64_tr_b16 v[148:149], v25 offset:9216
    s_waitcnt vmcnt(7)
    v_mfma_f32_32x32x16_bf16 v[150:165], v[94:97], v[198:201], v[150:165]
    v_mfma_f32_32x32x16_bf16 v[166:181], v[98:101], v[198:201], v[166:181]
    s_waitcnt vmcnt(6)
    v_mfma_f32_32x32x16_bf16 v[150:165], v[102:105], v[202:205], v[150:165]
    v_mfma_f32_32x32x16_bf16 v[166:181], v[106:109], v[202:205], v[166:181]
    s_waitcnt vmcnt(5)
    v_mfma_f32_32x32x16_bf16 v[150:165], v[110:113], v[206:209], v[150:165]
    s_waitcnt lgkmcnt(14)
    v_mfma_f32_32x32x16_bf16 v[166:181], v[114:117], v[206:209], v[166:181]
    s_mov_b32 s38, 0
L_Cc_24:
    s_waitcnt vmcnt(0)
    v_cmp_ne_u32 vcc, s46, v5
    s_nop 0
    s_cmp_eq_u64 vcc, 0
    s_cbranch_scc1 L_Cd_25
    s_add_u32 s38, s38, 1
    s_cmp_lt_u32 s38, 0x40000
    s_cbranch_scc0 L_C_23
    buffer_load_dword v5, v27, s[20:23], 0 offen sc1
    s_waitcnt vmcnt(0)
    s_branch L_Cc_24
L_C_23:
    v_mov_b32 v14, 0
    v_mov_b32 v15, 0xdead
    global_store_dword v14, v15, s[92:93]
L_Cd_25:
    s_lshl_b32 s56, s48, 18
    s_lshl_b32 s57, s47, 7
    s_add_u32 s56, s56, s57
    s_add_u32 s56, s56, 10485760
    s_add_u32 s57, s56, 131072
    buffer_load_dwordx4 v[6:9], v30, s[20:23], s56 offen sc1
    buffer_load_dwordx4 v[10:13], v30, s[20:23], s57 offen sc1
    v_mfma_f32_32x32x16_bf16 v[150:165], v[118:121], v[210:213], v[150:165]
    s_waitcnt lgkmcnt(12)
    v_mfma_f32_32x32x16_bf16 v[166:181], v[122:125], v[210:213], v[166:181]
    s_waitcnt lgkmcnt(10)
    v_mfma_f32_32x32x16_bf16 v[150:165], v[126:129], v[214:217], v[150:165]
    s_waitcnt lgkmcnt(8)
    v_mfma_f32_32x32x16_bf16 v[166:181], v[130:133], v[214:217], v[166:181]
    s_waitcnt lgkmcnt(6)
    v_mfma_f32_32x32x16_bf16 v[150:165], v[134:137], v[218:221], v[150:165]
    s_waitcnt lgkmcnt(4)
    v_mfma_f32_32x32x16_bf16 v[166:181], v[138:141], v[218:221], v[166:181]
    s_waitcnt lgkmcnt(2)
    v_mfma_f32_32x32x16_bf16 v[150:165], v[142:145], v[222:225], v[150:165]
    s_waitcnt lgkmcnt(0)
    v_mfma_f32_32x32x16_bf16 v[166:181], v[146:149], v[222:225], v[166:181]
    s_barrier
    s_cmp_eq_u32 s32, 0
    s_cbranch_scc0 L_g20_26
    s_nop 8
    ds_write_b128 v28, v[166:169] offset:0
    ds_write_b128 v28, v[170:173] offset:1024
    ds_write_b128 v28, v[174:177] offset:2048
    ds_write_b128 v28, v[178:181] offset:3072
    s_branch L_g21_27
L_g20_26:
    s_nop 5
    ds_write_b128 v28, v[150:153] offset:0
    ds_write_b128 v28, v[154:157] offset:1024
    ds_write_b128 v28, v[158:161] offset:2048
    ds_write_b128 v28, v[162:165] offset:3072
    v_pk_mul_f32 v[150:151], v[166:167], 1.0 op_sel_hi:[1,0]
    v_pk_mul_f32 v[152:153], v[168:169], 1.0 op_sel_hi:[1,0]
    v_pk_mul_f32 v[154:155], v[170:171], 1.0 op_sel_hi:[1,0]
    v_pk_mul_f32 v[156:157], v[172:173], 1.0 op_sel_hi:[1,0]
    v_pk_mul_f32 v[158:159], v[174:175], 1.0 op_sel_hi:[1,0]
    v_pk_mul_f32 v[160:161], v[176:177], 1.0 op_sel_hi:[1,0]
    v_pk_mul_f32 v[162:163], v[178:179], 1.0 op_sel_hi:[1,0]
    v_pk_mul_f32 v[164:165], v[180:181], 1.0 op_sel_hi:[1,0]
L_g21_27:
    s_waitcnt vmcnt(1)
    ds_write_b128 v31, v[6:9]
    s_waitcnt vmcnt(0)
    ds_write_b128 v31, v[10:13] offset:4608
    s_waitcnt lgkmcnt(0)
    s_barrier
    ds_read_b128 v[62:65], v29 offset:0
    ds_read_b128 v[66:69], v29 offset:1024
    ds_read_b128 v[70:73], v29 offset:2048
    ds_read_b128 v[74:77], v29 offset:3072
    ds_read_b64_tr_b16 v[6:7], v32 offset:0
    ds_read_b64_tr_b16 v[8:9], v32 offset:1152
    ds_read_b64_tr_b16 v[10:11], v32 offset:2304
    ds_read_b64_tr_b16 v[12:13], v32 offset:3456
    s_mov_b32 s34, 0xbfb8aa3b
    s_waitcnt lgkmcnt(7)
    v_pk_add_f32 v[150:151], v[150:151], v[62:63]
    v_pk_add_f32 v[152:153], v[152:153], v[64:65]
    s_waitcnt lgkmcnt(6)
    v_pk_add_f32 v[154:155], v[154:155], v[66:67]
    v_pk_add_f32 v[156:157], v[156:157], v[68:69]
    s_waitcnt lgkmcnt(5)
    v_pk_add_f32 v[158:159], v[158:159], v[70:71]
    v_pk_add_f32 v[160:161], v[160:161], v[72:73]
    s_waitcnt lgkmcnt(4)
    v_pk_add_f32 v[162:163], v[162:163], v[74:75]
    v_pk_add_f32 v[164:165], v[164:165], v[76:77]
    v_pk_mul_f32 v[62:63], v[150:151], s[34:35] op_sel_hi:[1,0]
    v_pk_mul_f32 v[64:65], v[152:153], s[34:35] op_sel_hi:[1,0]
    v_pk_mul_f32 v[66:67], v[154:155], s[34:35] op_sel_hi:[1,0]
    v_pk_mul_f32 v[68:69], v[156:157], s[34:35] op_sel_hi:[1,0]
    v_pk_mul_f32 v[70:71], v[158:159], s[34:35] op_sel_hi:[1,0]
    v_pk_mul_f32 v[72:73], v[160:161], s[34:35] op_sel_hi:[1,0]
    v_pk_mul_f32 v[74:75], v[162:163], s[34:35] op_sel_hi:[1,0]
    v_pk_mul_f32 v[76:77], v[164:165], s[34:35] op_sel_hi:[1,0]
    v_exp_f32 v62, v62
    v_exp_f32 v63, v63
    v_exp_f32 v64, v64
    v_exp_f32 v65, v65
    v_exp_f32 v66, v66
    v_exp_f32 v67, v67
    v_exp_f32 v68, v68
    v_exp_f32 v69, v69
    v_exp_f32 v70, v70
    v_exp_f32 v71, v71
    v_exp_f32 v72, v72
    v_exp_f32 v73, v73
    v_exp_f32 v74, v74
    v_exp_f32 v75, v75
    v_exp_f32 v76, v76
    v_exp_f32 v77, v77
    v_pk_add_f32 v[62:63], v[62:63], 1.0 op_sel_hi:[1,0]
    v_pk_add_f32 v[64:65], v[64:65], 1.0 op_sel_hi:[1,0]
    v_pk_add_f32 v[66:67], v[66:67], 1.0 op_sel_hi:[1,0]
    v_pk_add_f32 v[68:69], v[68:69], 1.0 op_sel_hi:[1,0]
    v_pk_add_f32 v[70:71], v[70:71], 1.0 op_sel_hi:[1,0]
    v_pk_add_f32 v[72:73], v[72:73], 1.0 op_sel_hi:[1,0]
    v_pk_add_f32 v[74:75], v[74:75], 1.0 op_sel_hi:[1,0]
    v_pk_add_f32 v[76:77], v[76:77], 1.0 op_sel_hi:[1,0]
    v_rcp_f32 v62, v62
    v_rcp_f32 v63, v63
    v_rcp_f32 v64, v64
    v_rcp_f32 v65, v65
    v_rcp_f32 v66, v66
    v_rcp_f32 v67, v67
    v_rcp_f32 v68, v68
    v_rcp_f32 v69, v69
    v_rcp_f32 v70, v70
    v_rcp_f32 v71, v71
    v_rcp_f32 v72, v72
    v_rcp_f32 v73, v73
    v_rcp_f32 v74, v74
    v_rcp_f32 v75, v75
    v_rcp_f32 v76, v76
    v_rcp_f32 v77, v77
    v_pk_mul_f32 v[150:151], v[150:151], v[62:63]
    v_pk_mul_f32 v[152:153], v[152:153], v[64:65]
    v_pk_mul_f32 v[154:155], v[154:155], v[66:67]
    v_pk_mul_f32 v[156:157], v[156:157], v[68:69]
    v_pk_mul_f32 v[158:159], v[158:159], v[70:71]
    v_pk_mul_f32 v[160:161], v[160:161], v[72:73]
    v_pk_mul_f32 v[162:163], v[162:163], v[74:75]
    v_pk_mul_f32 v[164:165], v[164:165], v[76:77]
    s_waitcnt lgkmcnt(3)
    v_lshlrev_b32 v62, 16, v6
    v_and_b32 v63, 0xffff0000, v6
    v_lshlrev_b32 v64, 16, v7
    v_and_b32 v65, 0xffff0000, v7
    s_waitcnt lgkmcnt(2)
    v_lshlrev_b32 v66, 16, v8
    v_and_b32 v67, 0xffff0000, v8
    v_lshlrev_b32 v68, 16, v9
    v_and_b32 v69, 0xffff0000, v9
    s_waitcnt lgkmcnt(1)
    v_lshlrev_b32 v70, 16, v10
    v_and_b32 v71, 0xffff0000, v10
    v_lshlrev_b32 v72, 16, v11
    v_and_b32 v73, 0xffff0000, v11
    s_waitcnt lgkmcnt(0)
    v_lshlrev_b32 v74, 16, v12
    v_and_b32 v75, 0xffff0000, v12
    v_lshlrev_b32 v76, 16, v13
    v_and_b32 v77, 0xffff0000, v13
    v_pk_mul_f32 v[150:151], v[150:151], v[62:63]
    v_pk_mul_f32 v[152:153], v[152:153], v[64:65]
    v_pk_mul_f32 v[154:155], v[154:155], v[66:67]
    v_pk_mul_f32 v[156:157], v[156:157], v[68:69]
    v_pk_mul_f32 v[158:159], v[158:159], v[70:71]
    v_pk_mul_f32 v[160:161], v[160:161], v[72:73]
    v_pk_mul_f32 v[162:163], v[162:163], v[74:75]
    v_pk_mul_f32 v[164:165], v[164:165], v[76:77]
    v_lshlrev_b32 v62, 16, v34
    v_and_b32 v63, 0xffff0000, v34
    v_lshlrev_b32 v64, 16, v35
    v_and_b32 v65, 0xffff0000, v35
    v_lshlrev_b32 v66, 16, v36
    v_and_b32 v67, 0xffff0000, v36
    v_lshlrev_b32 v68, 16, v37
    v_and_b32 v69, 0xffff0000, v37
    v_lshlrev_b32 v70, 16, v38
    v_and_b32 v71, 0xffff0000, v38
    v_lshlrev_b32 v72, 16, v39
    v_and_b32 v73, 0xffff0000, v39
    v_lshlrev_b32 v74, 16, v40
    v_and_b32 v75, 0xffff0000, v40
    v_lshlrev_b32 v76, 16, v41
    v_and_b32 v77, 0xffff0000, v41
    v_pk_add_f32 v[150:151], v[150:151], v[62:63]
    v_pk_add_f32 v[152:153], v[152:153], v[64:65]
    v_pk_add_f32 v[154:155], v[154:155], v[66:67]
    v_pk_add_f32 v[156:157], v[156:157], v[68:69]
    v_pk_add_f32 v[158:159], v[158:159], v[70:71]
    v_pk_add_f32 v[160:161], v[160:161], v[72:73]
    v_pk_add_f32 v[162:163], v[162:163], v[74:75]
    v_pk_add_f32 v[164:165], v[164:165], v[76:77]
    v_cvt_pk_bf16_f32 v34, v150, v151
    v_cvt_pk_bf16_f32 v35, v152, v153
    buffer_store_dwordx2 v[34:35], v33, s[24:27], s39 offen offset:0
    v_cvt_pk_bf16_f32 v36, v154, v155
    v_cvt_pk_bf16_f32 v37, v156, v157
    buffer_store_dwordx2 v[36:37], v33, s[24:27], s39 offen offset:16
    v_cvt_pk_bf16_f32 v38, v158, v159
    v_cvt_pk_bf16_f32 v39, v160, v161
    buffer_store_dwordx2 v[38:39], v33, s[24:27], s39 offen offset:32
    v_cvt_pk_bf16_f32 v40, v162, v163
    v_cvt_pk_bf16_f32 v41, v164, v165
    buffer_store_dwordx2 v[40:41], v33, s[24:27], s39 offen offset:48
L_end:
    s_endpgm

.section .rodata,"a"
.p2align 6
.amdhsa_kernel recurrent_scan__ssm_conv_s4d__dense_activation_mish__prompt_kernel
  .amdhsa_next_free_vgpr 512
  .amdhsa_next_free_sgpr 102
  .amdhsa_accum_offset 256
  .amdhsa_group_segment_fixed_size 0
  .amdhsa_kernarg_size 112
  .amdhsa_user_sgpr_count 2
  .amdhsa_user_sgpr_kernarg_segment_ptr 1
  .amdhsa_system_sgpr_workgroup_id_x 1
  .amdhsa_ieee_mode 0
  .amdhsa_dx10_clamp 0
.end_amdhsa_kernel
```
